```python
import torch

def _softmax(x, axis=-1):
    return torch.softmax(x, dim=axis)
def _gelu(x):
    return torch.nn.functional.gelu(x, approximate="tanh")
def _silu(x):
    return torch.nn.functional.silu(x)
def _sigmoid(x):
    return torch.sigmoid(x)
def _layernorm(x, axis=-1, eps=1e-5):
    m = x.mean(dim=axis, keepdim=True)
    v = x.var(dim=axis, keepdim=True, unbiased=False)
    return (x - m) / torch.sqrt(v + eps)
def _scatter_add(tgt, idx, src, axis=0):
    return tgt.clone().index_add_(axis, idx, src)
def _segment_sum(src, seg, n):
    out = torch.zeros((n,) + src.shape[1:], dtype=src.dtype)
    return out.index_add_(0, seg, src)
def _pad(x, pw):
    flat = tuple(v for pair in reversed(pw) for v in pair)
    return torch.nn.functional.pad(x, flat)

kernel_name = 'gated_mix__mha_block_cached__glu_gated_swiglu__decode'

def setup_inputs():

    _w = (lambda a: (lambda t: t.to(torch.bfloat16) if t.is_floating_point() else t)(torch.as_tensor(a)))
    def _A_setup():
        B, Sq, D = 1, 1, 640
        H, Sk, Dh = 32, 8192, 192
        return {
            "x": _w((lambda *s: torch.randn(*s, dtype=torch.bfloat16) * 0.05)(B, Sq, D)),
            "k_cache": _w((lambda *s: torch.randn(*s, dtype=torch.bfloat16) * 3.2)(B, H, Sk, Dh)),
            "v_cache": _w((lambda *s: torch.randn(*s, dtype=torch.bfloat16) * 0.2)(B, H, Sk, Dh)),
            "wq": _w((lambda *s: torch.randn(*s, dtype=torch.bfloat16) * 3.2)(D, H * Dh) * (D ** -0.5)),
            "wo": _w((lambda *s: torch.randn(*s, dtype=torch.bfloat16) * 0.2)(H * Dh, D) * ((H * Dh) ** -0.5)),
        }
    _A_in = _A_setup()

    def _B_setup():
        B, S, D, F = 1, 1, 640, 1536
        return {
            "x": _w((lambda *s: torch.randn(*s, dtype=torch.bfloat16) * 0.05)(B, S, D)),
            "w1": _w((lambda *s: torch.randn(*s, dtype=torch.bfloat16) * 0.4)(D, F) * (2.0 / D) ** 0.5),
            "w3": _w((lambda *s: torch.randn(*s, dtype=torch.bfloat16) * 0.4)(D, F) * (2.0 / D) ** 0.5),
            "w2": _w((lambda *s: torch.randn(*s, dtype=torch.bfloat16) * 0.4)(F, D) * (2.0 / F) ** 0.5),
        }
    _B_in = _B_setup()

    return {
        "A_x": _A_in["x"],
        "A_k_cache": _A_in["k_cache"],
        "A_v_cache": _A_in["v_cache"],
        "A_wq": _A_in["wq"],
        "A_wo": _A_in["wo"],
        "B_x": _B_in["x"],
        "B_w1": _B_in["w1"],
        "B_w3": _B_in["w3"],
        "B_w2": _B_in["w2"],
        "gate_w": _w((lambda *s: torch.randn(*s, dtype=torch.bfloat16) * 0.05)(640) * 16.0),
    }

def reference(A_x, A_k_cache, A_v_cache, A_wq, A_wo, B_x, B_w1, B_w3, B_w2, gate_w):
    def _A_ref(x, k_cache, v_cache, wq, wo):
        B, Sq, D = x.shape
        H, Dh = 32, 192
        q = (lambda x, *d: x.permute(*d))((x @ wq).reshape(B, Sq, H, Dh), 0, 2, 1, 3)
        scores = torch.einsum("bhqd,bhkd->bhqk", q, k_cache) * (Dh ** -0.5)
        p = _softmax(scores, axis=-1)
        o = torch.einsum("bhqk,bhkd->bhqd", p, v_cache)
        return (lambda x, *d: x.permute(*d))(o, 0, 2, 1, 3).reshape(B, Sq, H * Dh) @ wo

    def _B_ref(x, w1, w3, w2):
        gate = torch.einsum("bsd,df->bsf", x, w1)
        up = torch.einsum("bsd,df->bsf", x, w3)
        h = _silu(gate) * up
        out = torch.einsum("bsf,fd->bsd", h, w2)
        return out

    x = A_x
    g = _sigmoid((x * gate_w).sum(-1, keepdims=True))
    a = _A_ref(x, A_k_cache, A_v_cache, A_wq, A_wo)
    b = _B_ref(x, B_w1, B_w3, B_w2)
    return g * a + (1 - g) * b
```

```asm
; @launch grid=(256,1,1) block=(640,1,1) lds=37888
.amdgcn_target "amdgcn-amd-amdhsa--gfx950"
.text
.globl gated_mix__mha_block_cached__glu_gated_swiglu__decode_kernel
.p2align 8
.type gated_mix__mha_block_cached__glu_gated_swiglu__decode_kernel,@function
gated_mix__mha_block_cached__glu_gated_swiglu__decode_kernel:
    s_cmp_ge_u32 s2, 256
    s_cbranch_scc1 L_end
    s_load_dwordx16 s[4:19], s[0:1], 0
    s_load_dwordx8 s[20:27], s[0:1], 64
    s_load_dwordx2 s[28:29], s[0:1], 96
    s_lshr_b32 s80, s2, 3
    s_and_b32 s81, s2, 7
    v_lshrrev_b32 v76, 6, v0
    v_and_b32 v3, 63, v0
    v_readfirstlane_b32 s82, v76
    s_mov_b32 s84, 0xffff0000
    s_mov_b32 s85, 0x3fb8aa3b
    s_mov_b32 s86, 0x3d93cd3a
    v_and_b32 v58, 15, v3
    v_lshrrev_b32 v59, 4, v3
    v_cmp_gt_u32 s[88:89], 8, v58
    v_bfe_u32 v60, v3, 2, 2
    v_mul_u32_u24 v60, 768, v60
    v_lshl_add_u32 v60, v59, 6, v60
    v_and_b32 v61, 3, v3
    v_lshl_add_u32 v1, v61, 4, v60
    v_mul_u32_u24 v60, 768, v59
    v_lshl_add_u32 v2, v58, 4, v60
    s_and_b32 s87, s81, 1
    s_sub_u32 s92, 14, s87
    s_lshr_b32 s3, s81, 1
    s_mul_i32 s3, s3, 208
    s_mul_i32 s93, s87, 108
    s_add_u32 s3, s3, s93
    s_mul_i32 s93, s82, s92
    s_add_u32 s3, s3, s93
    s_sub_u32 s93, s82, 4
    s_cmp_ge_u32 s82, 4
    s_cselect_b32 s93, s93, 0
    s_cselect_b32 s87, 1, 0
    s_sub_u32 s3, s3, s93
    s_sub_u32 s92, s92, s87
    s_mul_i32 s3, s3, 3072
    s_cmp_ge_u32 s92, 13
    s_cselect_b32 s98, s3, 0x80000000
    s_cmp_ge_u32 s92, 14
    s_cselect_b32 s99, s3, 0x80000000
    s_mul_i32 s87, s80, 5462
    s_lshr_b32 s87, s87, 16
    s_mul_i32 s87, s87, 12
    s_sub_u32 s87, s80, s87
    s_mul_i32 s87, s87, 3072
    s_add_u32 s30, s3, s87
    s_add_u32 s31, s3, 36864
    s_waitcnt lgkmcnt(0)
    s_lshl_b32 s95, s80, 3
    s_add_u32 s95, s95, s81
    s_mul_i32 s92, s80, 3145728
    s_add_u32 s32, s6, s92
    s_addc_u32 s33, s7, 0
    s_and_b32 s33, s33, 0xffff
    s_mov_b32 s34, 3145728
    s_mov_b32 s35, 0x00020000
    s_cmp_ge_u32 s82, 8
    s_cbranch_scc1 L_skipk
    s_add_u32 s83, s30, 0
    s_sub_u32 s87, s83, 36864
    s_cmp_ge_u32 s83, s31
    s_cselect_b32 s83, s87, s83
    buffer_load_dwordx4 v[8:11], v1, s[32:35], s83 offen offset:0 nt
    buffer_load_dwordx4 v[12:15], v1, s[32:35], s83 offen offset:256 nt
    buffer_load_dwordx4 v[16:19], v1, s[32:35], s83 offen offset:512 nt
L_skipk:
    s_add_u32 s36, s8, s92
    s_addc_u32 s37, s9, 0
    s_and_b32 s37, s37, 0xffff
    s_mov_b32 s38, 3145728
    s_mov_b32 s39, 0x00020000
    s_mov_b32 s60, s4
    s_and_b32 s61, s5, 0xffff
    s_mov_b32 s62, 1280
    s_mov_b32 s63, 0x00020000
    s_mov_b32 s64, s22
    s_and_b32 s65, s23, 0xffff
    s_mov_b32 s66, 1280
    s_mov_b32 s67, 0x00020000
    s_mul_i32 s92, s80, 384
    s_add_u32 s40, s10, s92
    s_addc_u32 s41, s11, 0
    s_and_b32 s41, s41, 0xffff
    s_sub_u32 s42, 7864320, s92
    s_mov_b32 s43, 0x00020000
    s_lshr_b32 s14, s80, 2
    s_mul_i32 s14, s14, 192
    s_and_b32 s92, s80, 3
    s_lshl_b32 s92, s92, 6
    s_add_u32 s14, s14, s92
    s_cmp_eq_u32 s92, 192
    s_cselect_b32 s14, 0, s14
    s_cselect_b32 s15, 0, 1
    s_lshl_b32 s92, s14, 1
    s_add_u32 s48, s16, s92
    s_addc_u32 s49, s17, 0
    s_and_b32 s49, s49, 0xffff
    s_sub_u32 s50, 1966080, s92
    s_mov_b32 s51, 0x00020000
    s_add_u32 s52, s18, s92
    s_addc_u32 s53, s19, 0
    s_and_b32 s53, s53, 0xffff
    s_sub_u32 s54, 1966080, s92
    s_mov_b32 s55, 0x00020000
    s_mov_b32 s76, s28
    s_and_b32 s77, s29, 0xffff
    s_mov_b32 s78, 888832
    s_mov_b32 s79, 0x00020000
    s_mov_b32 s72, s26
    s_and_b32 s73, s27, 0xffff
    s_mov_b32 s74, 256
    s_mov_b32 s75, 0x00020000
    s_mov_b32 s68, s24
    s_and_b32 s69, s25, 0xffff
    s_mov_b32 s70, 1280
    s_mov_b32 s71, 0x00020000
    s_mul_i32 s92, s80, 245760
    s_lshr_b32 s100, s81, 2
    s_mul_i32 s100, s100, 640
    s_and_b32 s93, s81, 3
    s_cmp_eq_u32 s93, 0
    s_cselect_b32 s101, 16, 8
    s_lshl_b32 s93, s93, 7
    s_add_u32 s93, s93, 128
    s_cmp_eq_u32 s101, 16
    s_cselect_b32 s93, 0, s93
    s_add_u32 s100, s100, s93
    s_mov_b32 s93, s100
    s_add_u32 s92, s92, s93
    s_add_u32 s44, s12, s92
    s_addc_u32 s45, s13, 0
    s_and_b32 s45, s45, 0xffff
    s_sub_u32 s46, 7864320, s92
    s_mov_b32 s47, 0x00020000
    s_mul_i32 s92, s14, 1280
    s_add_u32 s92, s92, s93
    s_add_u32 s56, s20, s92
    s_addc_u32 s57, s21, 0
    s_and_b32 s57, s57, 0xffff
    s_sub_u32 s58, 1966080, s92
    s_mov_b32 s59, 0x00020000
    s_cmp_ge_u32 s82, 8
    s_cbranch_scc1 L_helper
    s_barrier
    s_waitcnt vmcnt(2)
    s_add_u32 s83, s30, 3072
    s_sub_u32 s87, s83, 36864
    s_cmp_ge_u32 s83, s31
    s_cselect_b32 s83, s87, s83
    buffer_load_dwordx4 v[20:23], v1, s[32:35], s83 offen offset:0 nt
    s_waitcnt vmcnt(2)
    buffer_load_dwordx4 v[24:27], v1, s[32:35], s83 offen offset:256 nt
    s_waitcnt vmcnt(2)
    buffer_load_dwordx4 v[28:31], v1, s[32:35], s83 offen offset:512 nt
    s_waitcnt vmcnt(2)
    s_add_u32 s83, s30, 6144
    s_sub_u32 s87, s83, 36864
    s_cmp_ge_u32 s83, s31
    s_cselect_b32 s83, s87, s83
    buffer_load_dwordx4 v[32:35], v1, s[32:35], s83 offen offset:0 nt
    s_waitcnt vmcnt(2)
    buffer_load_dwordx4 v[36:39], v1, s[32:35], s83 offen offset:256 nt
    s_waitcnt vmcnt(2)
    buffer_load_dwordx4 v[40:43], v1, s[32:35], s83 offen offset:512 nt
    s_waitcnt vmcnt(2)
    s_add_u32 s83, s30, 9216
    s_sub_u32 s87, s83, 36864
    s_cmp_ge_u32 s83, s31
    s_cselect_b32 s83, s87, s83
    buffer_load_dwordx4 v[88:91], v1, s[32:35], s83 offen offset:0 nt
    s_waitcnt vmcnt(2)
    buffer_load_dwordx4 v[92:95], v1, s[32:35], s83 offen offset:256 nt
    s_waitcnt vmcnt(2)
    buffer_load_dwordx4 v[96:99], v1, s[32:35], s83 offen offset:512 nt
    s_waitcnt vmcnt(2)
    s_add_u32 s83, s30, 12288
    s_sub_u32 s87, s83, 36864
    s_cmp_ge_u32 s83, s31
    s_cselect_b32 s83, s87, s83
    buffer_load_dwordx4 v[100:103], v1, s[32:35], s83 offen offset:0 nt
    s_waitcnt vmcnt(2)
    buffer_load_dwordx4 v[104:107], v1, s[32:35], s83 offen offset:256 nt
    s_waitcnt vmcnt(2)
    buffer_load_dwordx4 v[108:111], v1, s[32:35], s83 offen offset:512 nt
    s_waitcnt vmcnt(2)
    s_add_u32 s83, s30, 15360
    s_sub_u32 s87, s83, 36864
    s_cmp_ge_u32 s83, s31
    s_cselect_b32 s83, s87, s83
    buffer_load_dwordx4 v[112:115], v1, s[32:35], s83 offen offset:0 nt
    s_waitcnt vmcnt(2)
    buffer_load_dwordx4 v[116:119], v1, s[32:35], s83 offen offset:256 nt
    s_waitcnt vmcnt(2)
    buffer_load_dwordx4 v[120:123], v1, s[32:35], s83 offen offset:512 nt
    s_waitcnt vmcnt(2)
    s_add_u32 s83, s30, 18432
    s_sub_u32 s87, s83, 36864
    s_cmp_ge_u32 s83, s31
    s_cselect_b32 s83, s87, s83
    buffer_load_dwordx4 v[124:127], v1, s[32:35], s83 offen offset:0 nt
    s_waitcnt vmcnt(2)
    buffer_load_dwordx4 v[128:131], v1, s[32:35], s83 offen offset:256 nt
    s_waitcnt vmcnt(2)
    buffer_load_dwordx4 v[132:135], v1, s[32:35], s83 offen offset:512 nt
    s_waitcnt vmcnt(2)
    s_add_u32 s83, s30, 21504
    s_sub_u32 s87, s83, 36864
    s_cmp_ge_u32 s83, s31
    s_cselect_b32 s83, s87, s83
    buffer_load_dwordx4 v[136:139], v1, s[32:35], s83 offen offset:0 nt
    s_waitcnt vmcnt(2)
    buffer_load_dwordx4 v[140:143], v1, s[32:35], s83 offen offset:256 nt
    s_waitcnt vmcnt(2)
    buffer_load_dwordx4 v[144:147], v1, s[32:35], s83 offen offset:512 nt
    s_waitcnt vmcnt(2)
    s_add_u32 s83, s30, 24576
    s_sub_u32 s87, s83, 36864
    s_cmp_ge_u32 s83, s31
    s_cselect_b32 s83, s87, s83
    buffer_load_dwordx4 v[148:151], v1, s[32:35], s83 offen offset:0 nt
    s_waitcnt vmcnt(2)
    buffer_load_dwordx4 v[152:155], v1, s[32:35], s83 offen offset:256 nt
    s_waitcnt vmcnt(2)
    buffer_load_dwordx4 v[156:159], v1, s[32:35], s83 offen offset:512 nt
    s_waitcnt vmcnt(2)
    s_add_u32 s83, s30, 27648
    s_sub_u32 s87, s83, 36864
    s_cmp_ge_u32 s83, s31
    s_cselect_b32 s83, s87, s83
    buffer_load_dwordx4 v[160:163], v1, s[32:35], s83 offen offset:0 nt
    s_waitcnt vmcnt(2)
    buffer_load_dwordx4 v[164:167], v1, s[32:35], s83 offen offset:256 nt
    v_lshrrev_b32 v76, 4, v3
    s_lshl_b32 s87, s82, 2
    v_add_u32 v76, s87, v76
    v_mul_u32_u24 v76, 1280, v76
    v_and_b32 v77, 15, v3
    v_lshl_add_u32 v76, v77, 4, v76
    v_mov_b32 v78, 0x80000000
    v_cmp_gt_u32 vcc, s101, v77
    s_nop 1
    v_cndmask_b32 v84, v78, v76, vcc
    s_cmp_eq_u32 s15, 1
    s_cselect_b64 vcc, vcc, 0
    s_nop 1
    v_cndmask_b32 v85, v78, v76, vcc
    s_lshl_b32 s87, s80, 7
    s_add_u32 s87, s87, 884736
    v_mov_b32 v87, s87
    v_cmp_eq_u32 vcc, 0, v3
    v_mov_b32 v86, 1
    s_nop 0
    v_cndmask_b32 v87, v78, v87, vcc
    v_lshrrev_b32 v4, 4, v3
    v_and_b32 v5, 3, v3
    v_lshlrev_b32 v5, 4, v5
    v_lshl_add_u32 v5, v4, 6, v5
    v_add_u32 v5, 12864, v5
    v_mov_b32 v6, 13248
    v_cmp_gt_u32 vcc, 32, v3
    v_add_u32 v7, 256, v5
    v_subrev_u32 v4, 128, v5
    v_cndmask_b32 v7, v6, v7, vcc
    v_cndmask_b32 v4, v4, v6, vcc
    v_mov_b32 v81, 0xff800000
    s_barrier
    ds_read_b128 v[44:47], v5
    ds_read_b128 v[48:51], v7
    ds_read_b128 v[52:55], v4
    ds_read_b128 v[56:59], v5 offset:128
    s_waitcnt lgkmcnt(0)
    v_mfma_f32_16x16x32_bf16 v[60:63], v[8:11], v[44:47], 0
    v_mfma_f32_16x16x32_bf16 v[64:67], v[12:15], v[52:55], 0
    v_mfma_f32_16x16x32_bf16 v[60:63], v[12:15], v[48:51], v[60:63]
    v_mfma_f32_16x16x32_bf16 v[64:67], v[16:19], v[56:59], v[64:67]
    s_nop 7
    v_mfma_f32_16x16x32_bf16 v[68:71], v[20:23], v[44:47], 0
    v_mfma_f32_16x16x32_bf16 v[72:75], v[24:27], v[52:55], 0
    v_mfma_f32_16x16x32_bf16 v[68:71], v[24:27], v[48:51], v[68:71]
    v_mfma_f32_16x16x32_bf16 v[72:75], v[28:31], v[56:59], v[72:75]
    v_mov_b32_dpp v79, v60 quad_perm:[0,0,0,0] row_mask:0xf bank_mask:0xf
    v_mov_b32_dpp v80, v64 quad_perm:[0,0,0,0] row_mask:0xf bank_mask:0xf
    v_add_f32_dpp v79, v61, v79 quad_perm:[1,1,1,1] row_mask:0xf bank_mask:0xf
    v_add_f32_dpp v80, v65, v80 quad_perm:[1,1,1,1] row_mask:0xf bank_mask:0xf
    v_add_f32_dpp v79, v62, v79 quad_perm:[2,2,2,2] row_mask:0xf bank_mask:0xf
    v_add_f32_dpp v80, v66, v80 quad_perm:[2,2,2,2] row_mask:0xf bank_mask:0xf
    v_add_f32_dpp v79, v63, v79 quad_perm:[3,3,3,3] row_mask:0xf bank_mask:0xf
    v_add_f32_dpp v80, v67, v80 quad_perm:[3,3,3,3] row_mask:0xf bank_mask:0xf
    v_cvt_pk_bf16_f32 v79, v79, v80
    v_and_b32 v80, s84, v79
    v_lshlrev_b32 v79, 16, v79
    v_mul_f32 v79, s86, v79
    v_mul_f32 v80, s86, v80
    v_cvt_pk_bf16_f32 v4, v79, v80
    v_and_b32 v80, s84, v4
    v_lshlrev_b32 v79, 16, v4
    v_max3_f32 v81, v81, v79, v80
    v_mfma_f32_16x16x32_bf16 v[60:63], v[32:35], v[44:47], 0
    v_mfma_f32_16x16x32_bf16 v[64:67], v[36:39], v[52:55], 0
    v_mfma_f32_16x16x32_bf16 v[60:63], v[36:39], v[48:51], v[60:63]
    v_mfma_f32_16x16x32_bf16 v[64:67], v[40:43], v[56:59], v[64:67]
    v_mov_b32_dpp v79, v68 quad_perm:[0,0,0,0] row_mask:0xf bank_mask:0xf
    v_mov_b32_dpp v80, v72 quad_perm:[0,0,0,0] row_mask:0xf bank_mask:0xf
    v_add_f32_dpp v79, v69, v79 quad_perm:[1,1,1,1] row_mask:0xf bank_mask:0xf
    v_add_f32_dpp v80, v73, v80 quad_perm:[1,1,1,1] row_mask:0xf bank_mask:0xf
    v_add_f32_dpp v79, v70, v79 quad_perm:[2,2,2,2] row_mask:0xf bank_mask:0xf
    v_add_f32_dpp v80, v74, v80 quad_perm:[2,2,2,2] row_mask:0xf bank_mask:0xf
    v_add_f32_dpp v79, v71, v79 quad_perm:[3,3,3,3] row_mask:0xf bank_mask:0xf
    v_add_f32_dpp v80, v75, v80 quad_perm:[3,3,3,3] row_mask:0xf bank_mask:0xf
    v_cvt_pk_bf16_f32 v79, v79, v80
    v_and_b32 v80, s84, v79
    v_lshlrev_b32 v79, 16, v79
    v_mul_f32 v79, s86, v79
    v_mul_f32 v80, s86, v80
    v_cvt_pk_bf16_f32 v5, v79, v80
    v_and_b32 v80, s84, v5
    v_lshlrev_b32 v79, 16, v5
    v_max3_f32 v81, v81, v79, v80
    v_mfma_f32_16x16x32_bf16 v[68:71], v[88:91], v[44:47], 0
    v_mfma_f32_16x16x32_bf16 v[72:75], v[92:95], v[52:55], 0
    v_mfma_f32_16x16x32_bf16 v[68:71], v[92:95], v[48:51], v[68:71]
    v_mfma_f32_16x16x32_bf16 v[72:75], v[96:99], v[56:59], v[72:75]
    v_mov_b32_dpp v79, v60 quad_perm:[0,0,0,0] row_mask:0xf bank_mask:0xf
    v_mov_b32_dpp v80, v64 quad_perm:[0,0,0,0] row_mask:0xf bank_mask:0xf
    v_add_f32_dpp v79, v61, v79 quad_perm:[1,1,1,1] row_mask:0xf bank_mask:0xf
    v_add_f32_dpp v80, v65, v80 quad_perm:[1,1,1,1] row_mask:0xf bank_mask:0xf
    v_add_f32_dpp v79, v62, v79 quad_perm:[2,2,2,2] row_mask:0xf bank_mask:0xf
    v_add_f32_dpp v80, v66, v80 quad_perm:[2,2,2,2] row_mask:0xf bank_mask:0xf
    v_add_f32_dpp v79, v63, v79 quad_perm:[3,3,3,3] row_mask:0xf bank_mask:0xf
    v_add_f32_dpp v80, v67, v80 quad_perm:[3,3,3,3] row_mask:0xf bank_mask:0xf
    v_cvt_pk_bf16_f32 v79, v79, v80
    v_and_b32 v80, s84, v79
    v_lshlrev_b32 v79, 16, v79
    v_mul_f32 v79, s86, v79
    v_mul_f32 v80, s86, v80
    v_cvt_pk_bf16_f32 v6, v79, v80
    v_and_b32 v80, s84, v6
    v_lshlrev_b32 v79, 16, v6
    v_max3_f32 v81, v81, v79, v80
    buffer_load_dwordx4 v[88:91], v1, s[32:35], s83 offen offset:512 nt
    v_mfma_f32_16x16x32_bf16 v[60:63], v[100:103], v[44:47], 0
    v_mfma_f32_16x16x32_bf16 v[64:67], v[104:107], v[52:55], 0
    v_mfma_f32_16x16x32_bf16 v[60:63], v[104:107], v[48:51], v[60:63]
    v_mfma_f32_16x16x32_bf16 v[64:67], v[108:111], v[56:59], v[64:67]
    v_mov_b32_dpp v79, v68 quad_perm:[0,0,0,0] row_mask:0xf bank_mask:0xf
    v_mov_b32_dpp v80, v72 quad_perm:[0,0,0,0] row_mask:0xf bank_mask:0xf
    v_add_f32_dpp v79, v69, v79 quad_perm:[1,1,1,1] row_mask:0xf bank_mask:0xf
    v_add_f32_dpp v80, v73, v80 quad_perm:[1,1,1,1] row_mask:0xf bank_mask:0xf
    v_add_f32_dpp v79, v70, v79 quad_perm:[2,2,2,2] row_mask:0xf bank_mask:0xf
    v_add_f32_dpp v80, v74, v80 quad_perm:[2,2,2,2] row_mask:0xf bank_mask:0xf
    v_add_f32_dpp v79, v71, v79 quad_perm:[3,3,3,3] row_mask:0xf bank_mask:0xf
    v_add_f32_dpp v80, v75, v80 quad_perm:[3,3,3,3] row_mask:0xf bank_mask:0xf
    v_cvt_pk_bf16_f32 v79, v79, v80
    v_and_b32 v80, s84, v79
    v_lshlrev_b32 v79, 16, v79
    v_mul_f32 v79, s86, v79
    v_mul_f32 v80, s86, v80
    v_cvt_pk_bf16_f32 v7, v79, v80
    v_and_b32 v80, s84, v7
    v_lshlrev_b32 v79, 16, v7
    v_max3_f32 v81, v81, v79, v80
    s_add_u32 s83, s30, 30720
    s_sub_u32 s87, s83, 36864
    s_cmp_ge_u32 s83, s31
    s_cselect_b32 s83, s87, s83
    buffer_load_dwordx4 v[92:95], v1, s[32:35], s83 offen offset:0 nt
    v_mfma_f32_16x16x32_bf16 v[68:71], v[112:115], v[44:47], 0
    v_mfma_f32_16x16x32_bf16 v[72:75], v[116:119], v[52:55], 0
    v_mfma_f32_16x16x32_bf16 v[68:71], v[116:119], v[48:51], v[68:71]
    v_mfma_f32_16x16x32_bf16 v[72:75], v[120:123], v[56:59], v[72:75]
    v_mov_b32_dpp v79, v60 quad_perm:[0,0,0,0] row_mask:0xf bank_mask:0xf
    v_mov_b32_dpp v80, v64 quad_perm:[0,0,0,0] row_mask:0xf bank_mask:0xf
    v_add_f32_dpp v79, v61, v79 quad_perm:[1,1,1,1] row_mask:0xf bank_mask:0xf
    v_add_f32_dpp v80, v65, v80 quad_perm:[1,1,1,1] row_mask:0xf bank_mask:0xf
    v_add_f32_dpp v79, v62, v79 quad_perm:[2,2,2,2] row_mask:0xf bank_mask:0xf
    v_add_f32_dpp v80, v66, v80 quad_perm:[2,2,2,2] row_mask:0xf bank_mask:0xf
    v_add_f32_dpp v79, v63, v79 quad_perm:[3,3,3,3] row_mask:0xf bank_mask:0xf
    v_add_f32_dpp v80, v67, v80 quad_perm:[3,3,3,3] row_mask:0xf bank_mask:0xf
    v_cvt_pk_bf16_f32 v79, v79, v80
    v_and_b32 v80, s84, v79
    v_lshlrev_b32 v79, 16, v79
    v_mul_f32 v79, s86, v79
    v_mul_f32 v80, s86, v80
    v_cvt_pk_bf16_f32 v8, v79, v80
    v_and_b32 v80, s84, v8
    v_lshlrev_b32 v79, 16, v8
    v_max3_f32 v81, v81, v79, v80
    s_waitcnt vmcnt(4)
    buffer_load_dwordx4 v[96:99], v1, s[32:35], s83 offen offset:256 nt
    v_mfma_f32_16x16x32_bf16 v[60:63], v[124:127], v[44:47], 0
    v_mfma_f32_16x16x32_bf16 v[64:67], v[128:131], v[52:55], 0
    v_mfma_f32_16x16x32_bf16 v[60:63], v[128:131], v[48:51], v[60:63]
    v_mfma_f32_16x16x32_bf16 v[64:67], v[132:135], v[56:59], v[64:67]
    v_mov_b32_dpp v79, v68 quad_perm:[0,0,0,0] row_mask:0xf bank_mask:0xf
    v_mov_b32_dpp v80, v72 quad_perm:[0,0,0,0] row_mask:0xf bank_mask:0xf
    v_add_f32_dpp v79, v69, v79 quad_perm:[1,1,1,1] row_mask:0xf bank_mask:0xf
    v_add_f32_dpp v80, v73, v80 quad_perm:[1,1,1,1] row_mask:0xf bank_mask:0xf
    v_add_f32_dpp v79, v70, v79 quad_perm:[2,2,2,2] row_mask:0xf bank_mask:0xf
    v_add_f32_dpp v80, v74, v80 quad_perm:[2,2,2,2] row_mask:0xf bank_mask:0xf
    v_add_f32_dpp v79, v71, v79 quad_perm:[3,3,3,3] row_mask:0xf bank_mask:0xf
    v_add_f32_dpp v80, v75, v80 quad_perm:[3,3,3,3] row_mask:0xf bank_mask:0xf
    v_cvt_pk_bf16_f32 v79, v79, v80
    v_and_b32 v80, s84, v79
    v_lshlrev_b32 v79, 16, v79
    v_mul_f32 v79, s86, v79
    v_mul_f32 v80, s86, v80
    v_cvt_pk_bf16_f32 v9, v79, v80
    v_and_b32 v80, s84, v9
    v_lshlrev_b32 v79, 16, v9
    v_max3_f32 v81, v81, v79, v80
    s_waitcnt vmcnt(4)
    buffer_load_dwordx4 v[100:103], v1, s[32:35], s83 offen offset:512 nt
    v_mfma_f32_16x16x32_bf16 v[68:71], v[136:139], v[44:47], 0
    v_mfma_f32_16x16x32_bf16 v[72:75], v[140:143], v[52:55], 0
    v_mfma_f32_16x16x32_bf16 v[68:71], v[140:143], v[48:51], v[68:71]
    v_mfma_f32_16x16x32_bf16 v[72:75], v[144:147], v[56:59], v[72:75]
    v_mov_b32_dpp v79, v60 quad_perm:[0,0,0,0] row_mask:0xf bank_mask:0xf
    v_mov_b32_dpp v80, v64 quad_perm:[0,0,0,0] row_mask:0xf bank_mask:0xf
    v_add_f32_dpp v79, v61, v79 quad_perm:[1,1,1,1] row_mask:0xf bank_mask:0xf
    v_add_f32_dpp v80, v65, v80 quad_perm:[1,1,1,1] row_mask:0xf bank_mask:0xf
    v_add_f32_dpp v79, v62, v79 quad_perm:[2,2,2,2] row_mask:0xf bank_mask:0xf
    v_add_f32_dpp v80, v66, v80 quad_perm:[2,2,2,2] row_mask:0xf bank_mask:0xf
    v_add_f32_dpp v79, v63, v79 quad_perm:[3,3,3,3] row_mask:0xf bank_mask:0xf
    v_add_f32_dpp v80, v67, v80 quad_perm:[3,3,3,3] row_mask:0xf bank_mask:0xf
    v_cvt_pk_bf16_f32 v79, v79, v80
    v_and_b32 v80, s84, v79
    v_lshlrev_b32 v79, 16, v79
    v_mul_f32 v79, s86, v79
    v_mul_f32 v80, s86, v80
    v_cvt_pk_bf16_f32 v10, v79, v80
    v_and_b32 v80, s84, v10
    v_lshlrev_b32 v79, 16, v10
    v_max3_f32 v81, v81, v79, v80
    s_waitcnt vmcnt(4)
    s_add_u32 s83, s30, 33792
    s_sub_u32 s87, s83, 36864
    s_cmp_ge_u32 s83, s31
    s_cselect_b32 s83, s87, s83
    buffer_load_dwordx4 v[104:107], v1, s[32:35], s83 offen offset:0 nt
    v_mfma_f32_16x16x32_bf16 v[60:63], v[148:151], v[44:47], 0
    v_mfma_f32_16x16x32_bf16 v[64:67], v[152:155], v[52:55], 0
    v_mfma_f32_16x16x32_bf16 v[60:63], v[152:155], v[48:51], v[60:63]
    v_mfma_f32_16x16x32_bf16 v[64:67], v[156:159], v[56:59], v[64:67]
    v_mov_b32_dpp v79, v68 quad_perm:[0,0,0,0] row_mask:0xf bank_mask:0xf
    v_mov_b32_dpp v80, v72 quad_perm:[0,0,0,0] row_mask:0xf bank_mask:0xf
    v_add_f32_dpp v79, v69, v79 quad_perm:[1,1,1,1] row_mask:0xf bank_mask:0xf
    v_add_f32_dpp v80, v73, v80 quad_perm:[1,1,1,1] row_mask:0xf bank_mask:0xf
    v_add_f32_dpp v79, v70, v79 quad_perm:[2,2,2,2] row_mask:0xf bank_mask:0xf
    v_add_f32_dpp v80, v74, v80 quad_perm:[2,2,2,2] row_mask:0xf bank_mask:0xf
    v_add_f32_dpp v79, v71, v79 quad_perm:[3,3,3,3] row_mask:0xf bank_mask:0xf
    v_add_f32_dpp v80, v75, v80 quad_perm:[3,3,3,3] row_mask:0xf bank_mask:0xf
    v_cvt_pk_bf16_f32 v79, v79, v80
    v_and_b32 v80, s84, v79
    v_lshlrev_b32 v79, 16, v79
    v_mul_f32 v79, s86, v79
    v_mul_f32 v80, s86, v80
    v_cvt_pk_bf16_f32 v11, v79, v80
    v_and_b32 v80, s84, v11
    v_lshlrev_b32 v79, 16, v11
    v_max3_f32 v81, v81, v79, v80
    s_waitcnt vmcnt(4)
    buffer_load_dwordx4 v[108:111], v1, s[32:35], s83 offen offset:256 nt
    v_mfma_f32_16x16x32_bf16 v[68:71], v[160:163], v[44:47], 0
    v_mfma_f32_16x16x32_bf16 v[72:75], v[164:167], v[52:55], 0
    v_mfma_f32_16x16x32_bf16 v[68:71], v[164:167], v[48:51], v[68:71]
    v_mfma_f32_16x16x32_bf16 v[72:75], v[88:91], v[56:59], v[72:75]
    v_mov_b32_dpp v79, v60 quad_perm:[0,0,0,0] row_mask:0xf bank_mask:0xf
    v_mov_b32_dpp v80, v64 quad_perm:[0,0,0,0] row_mask:0xf bank_mask:0xf
    v_add_f32_dpp v79, v61, v79 quad_perm:[1,1,1,1] row_mask:0xf bank_mask:0xf
    v_add_f32_dpp v80, v65, v80 quad_perm:[1,1,1,1] row_mask:0xf bank_mask:0xf
    v_add_f32_dpp v79, v62, v79 quad_perm:[2,2,2,2] row_mask:0xf bank_mask:0xf
    v_add_f32_dpp v80, v66, v80 quad_perm:[2,2,2,2] row_mask:0xf bank_mask:0xf
    v_add_f32_dpp v79, v63, v79 quad_perm:[3,3,3,3] row_mask:0xf bank_mask:0xf
    v_add_f32_dpp v80, v67, v80 quad_perm:[3,3,3,3] row_mask:0xf bank_mask:0xf
    v_cvt_pk_bf16_f32 v79, v79, v80
    v_and_b32 v80, s84, v79
    v_lshlrev_b32 v79, 16, v79
    v_mul_f32 v79, s86, v79
    v_mul_f32 v80, s86, v80
    v_cvt_pk_bf16_f32 v12, v79, v80
    v_and_b32 v80, s84, v12
    v_lshlrev_b32 v79, 16, v12
    v_max3_f32 v81, v81, v79, v80
    s_waitcnt vmcnt(4)
    buffer_load_dwordx4 v[88:91], v1, s[32:35], s83 offen offset:512 nt
    s_waitcnt vmcnt(4)
    s_add_u32 s83, s98, 36864
    buffer_load_dwordx4 v[112:115], v1, s[32:35], s83 offen offset:0 nt
    s_waitcnt vmcnt(4)
    s_add_u32 s83, s98, 36864
    buffer_load_dwordx4 v[116:119], v1, s[32:35], s83 offen offset:256 nt
    v_mfma_f32_16x16x32_bf16 v[60:63], v[92:95], v[44:47], 0
    v_mfma_f32_16x16x32_bf16 v[64:67], v[96:99], v[52:55], 0
    v_mfma_f32_16x16x32_bf16 v[60:63], v[96:99], v[48:51], v[60:63]
    v_mfma_f32_16x16x32_bf16 v[64:67], v[100:103], v[56:59], v[64:67]
    v_mov_b32_dpp v79, v68 quad_perm:[0,0,0,0] row_mask:0xf bank_mask:0xf
    v_mov_b32_dpp v80, v72 quad_perm:[0,0,0,0] row_mask:0xf bank_mask:0xf
    v_add_f32_dpp v79, v69, v79 quad_perm:[1,1,1,1] row_mask:0xf bank_mask:0xf
    v_add_f32_dpp v80, v73, v80 quad_perm:[1,1,1,1] row_mask:0xf bank_mask:0xf
    v_add_f32_dpp v79, v70, v79 quad_perm:[2,2,2,2] row_mask:0xf bank_mask:0xf
    v_add_f32_dpp v80, v74, v80 quad_perm:[2,2,2,2] row_mask:0xf bank_mask:0xf
    v_add_f32_dpp v79, v71, v79 quad_perm:[3,3,3,3] row_mask:0xf bank_mask:0xf
    v_add_f32_dpp v80, v75, v80 quad_perm:[3,3,3,3] row_mask:0xf bank_mask:0xf
    v_cvt_pk_bf16_f32 v79, v79, v80
    v_and_b32 v80, s84, v79
    v_lshlrev_b32 v79, 16, v79
    v_mul_f32 v79, s86, v79
    v_mul_f32 v80, s86, v80
    v_cvt_pk_bf16_f32 v13, v79, v80
    v_and_b32 v80, s84, v13
    v_lshlrev_b32 v79, 16, v13
    v_max3_f32 v81, v81, v79, v80
    s_waitcnt vmcnt(4)
    s_add_u32 s83, s98, 36864
    buffer_load_dwordx4 v[92:95], v1, s[32:35], s83 offen offset:512 nt
    s_waitcnt vmcnt(4)
    s_add_u32 s83, s99, 39936
    buffer_load_dwordx4 v[96:99], v1, s[32:35], s83 offen offset:0 nt
    s_waitcnt vmcnt(4)
    s_add_u32 s83, s99, 39936
    buffer_load_dwordx4 v[100:103], v1, s[32:35], s83 offen offset:256 nt
    v_mfma_f32_16x16x32_bf16 v[68:71], v[104:107], v[44:47], 0
    v_mfma_f32_16x16x32_bf16 v[72:75], v[108:111], v[52:55], 0
    v_mfma_f32_16x16x32_bf16 v[68:71], v[108:111], v[48:51], v[68:71]
    v_mfma_f32_16x16x32_bf16 v[72:75], v[88:91], v[56:59], v[72:75]
    v_mov_b32_dpp v79, v60 quad_perm:[0,0,0,0] row_mask:0xf bank_mask:0xf
    v_mov_b32_dpp v80, v64 quad_perm:[0,0,0,0] row_mask:0xf bank_mask:0xf
    v_add_f32_dpp v79, v61, v79 quad_perm:[1,1,1,1] row_mask:0xf bank_mask:0xf
    v_add_f32_dpp v80, v65, v80 quad_perm:[1,1,1,1] row_mask:0xf bank_mask:0xf
    v_add_f32_dpp v79, v62, v79 quad_perm:[2,2,2,2] row_mask:0xf bank_mask:0xf
    v_add_f32_dpp v80, v66, v80 quad_perm:[2,2,2,2] row_mask:0xf bank_mask:0xf
    v_add_f32_dpp v79, v63, v79 quad_perm:[3,3,3,3] row_mask:0xf bank_mask:0xf
    v_add_f32_dpp v80, v67, v80 quad_perm:[3,3,3,3] row_mask:0xf bank_mask:0xf
    v_cvt_pk_bf16_f32 v79, v79, v80
    v_and_b32 v80, s84, v79
    v_lshlrev_b32 v79, 16, v79
    v_mul_f32 v79, s86, v79
    v_mul_f32 v80, s86, v80
    v_cvt_pk_bf16_f32 v14, v79, v80
    v_and_b32 v80, s84, v14
    v_lshlrev_b32 v79, 16, v14
    v_max3_f32 v81, v81, v79, v80
    s_waitcnt vmcnt(4)
    s_add_u32 s83, s99, 39936
    buffer_load_dwordx4 v[88:91], v1, s[32:35], s83 offen offset:512 nt
    s_waitcnt vmcnt(4)
    s_add_u32 s83, s30, 0
    s_sub_u32 s87, s83, 36864
    s_cmp_ge_u32 s83, s31
    s_cselect_b32 s83, s87, s83
    buffer_load_dwordx4 v[104:107], v2, s[36:39], s83 offen offset:0 nt
    s_waitcnt vmcnt(4)
    buffer_load_dwordx4 v[108:111], v2, s[36:39], s83 offen offset:256 nt
    v_mfma_f32_16x16x32_bf16 v[60:63], v[112:115], v[44:47], 0
    v_mfma_f32_16x16x32_bf16 v[64:67], v[116:119], v[52:55], 0
    v_mfma_f32_16x16x32_bf16 v[60:63], v[116:119], v[48:51], v[60:63]
    v_mfma_f32_16x16x32_bf16 v[64:67], v[92:95], v[56:59], v[64:67]
    v_mov_b32_dpp v79, v68 quad_perm:[0,0,0,0] row_mask:0xf bank_mask:0xf
    v_mov_b32_dpp v80, v72 quad_perm:[0,0,0,0] row_mask:0xf bank_mask:0xf
    v_add_f32_dpp v79, v69, v79 quad_perm:[1,1,1,1] row_mask:0xf bank_mask:0xf
    v_add_f32_dpp v80, v73, v80 quad_perm:[1,1,1,1] row_mask:0xf bank_mask:0xf
    v_add_f32_dpp v79, v70, v79 quad_perm:[2,2,2,2] row_mask:0xf bank_mask:0xf
    v_add_f32_dpp v80, v74, v80 quad_perm:[2,2,2,2] row_mask:0xf bank_mask:0xf
    v_add_f32_dpp v79, v71, v79 quad_perm:[3,3,3,3] row_mask:0xf bank_mask:0xf
    v_add_f32_dpp v80, v75, v80 quad_perm:[3,3,3,3] row_mask:0xf bank_mask:0xf
    v_cvt_pk_bf16_f32 v79, v79, v80
    v_and_b32 v80, s84, v79
    v_lshlrev_b32 v79, 16, v79
    v_mul_f32 v79, s86, v79
    v_mul_f32 v80, s86, v80
    v_cvt_pk_bf16_f32 v15, v79, v80
    v_and_b32 v80, s84, v15
    v_lshlrev_b32 v79, 16, v15
    v_max3_f32 v81, v81, v79, v80
    s_waitcnt vmcnt(4)
    buffer_load_dwordx4 v[92:95], v2, s[36:39], s83 offen offset:512 nt
    s_waitcnt vmcnt(4)
    s_add_u32 s83, s30, 3072
    s_sub_u32 s87, s83, 36864
    s_cmp_ge_u32 s83, s31
    s_cselect_b32 s83, s87, s83
    buffer_load_dwordx4 v[112:115], v2, s[36:39], s83 offen offset:0 nt
    s_waitcnt vmcnt(4)
    buffer_load_dwordx4 v[116:119], v2, s[36:39], s83 offen offset:256 nt
    v_mfma_f32_16x16x32_bf16 v[68:71], v[96:99], v[44:47], 0
    v_mfma_f32_16x16x32_bf16 v[72:75], v[100:103], v[52:55], 0
    v_mfma_f32_16x16x32_bf16 v[68:71], v[100:103], v[48:51], v[68:71]
    v_mfma_f32_16x16x32_bf16 v[72:75], v[88:91], v[56:59], v[72:75]
    v_mov_b32_dpp v79, v60 quad_perm:[0,0,0,0] row_mask:0xf bank_mask:0xf
    v_mov_b32_dpp v80, v64 quad_perm:[0,0,0,0] row_mask:0xf bank_mask:0xf
    v_add_f32_dpp v79, v61, v79 quad_perm:[1,1,1,1] row_mask:0xf bank_mask:0xf
    v_add_f32_dpp v80, v65, v80 quad_perm:[1,1,1,1] row_mask:0xf bank_mask:0xf
    v_add_f32_dpp v79, v62, v79 quad_perm:[2,2,2,2] row_mask:0xf bank_mask:0xf
    v_add_f32_dpp v80, v66, v80 quad_perm:[2,2,2,2] row_mask:0xf bank_mask:0xf
    v_add_f32_dpp v79, v63, v79 quad_perm:[3,3,3,3] row_mask:0xf bank_mask:0xf
    v_add_f32_dpp v80, v67, v80 quad_perm:[3,3,3,3] row_mask:0xf bank_mask:0xf
    v_cvt_pk_bf16_f32 v79, v79, v80
    v_and_b32 v80, s84, v79
    v_lshlrev_b32 v79, 16, v79
    v_mul_f32 v79, s86, v79
    v_mul_f32 v80, s86, v80
    v_cvt_pk_bf16_f32 v16, v79, v80
    v_and_b32 v80, s84, v16
    v_lshlrev_b32 v79, 16, v16
    s_cmp_lg_u32 s98, 0x80000000
    s_cbranch_scc1 L_void_1a
    v_mov_b32 v16, 0xff80ff80
    s_branch L_void_1b
L_void_1a:
    v_max3_f32 v81, v81, v79, v80
L_void_1b:
    s_nop 1
    v_mov_b32_dpp v79, v68 quad_perm:[0,0,0,0] row_mask:0xf bank_mask:0xf
    v_mov_b32_dpp v80, v72 quad_perm:[0,0,0,0] row_mask:0xf bank_mask:0xf
    v_add_f32_dpp v79, v69, v79 quad_perm:[1,1,1,1] row_mask:0xf bank_mask:0xf
    v_add_f32_dpp v80, v73, v80 quad_perm:[1,1,1,1] row_mask:0xf bank_mask:0xf
    v_add_f32_dpp v79, v70, v79 quad_perm:[2,2,2,2] row_mask:0xf bank_mask:0xf
    v_add_f32_dpp v80, v74, v80 quad_perm:[2,2,2,2] row_mask:0xf bank_mask:0xf
    v_add_f32_dpp v79, v71, v79 quad_perm:[3,3,3,3] row_mask:0xf bank_mask:0xf
    v_add_f32_dpp v80, v75, v80 quad_perm:[3,3,3,3] row_mask:0xf bank_mask:0xf
    v_cvt_pk_bf16_f32 v79, v79, v80
    v_and_b32 v80, s84, v79
    v_lshlrev_b32 v79, 16, v79
    v_mul_f32 v79, s86, v79
    v_mul_f32 v80, s86, v80
    v_cvt_pk_bf16_f32 v17, v79, v80
    v_and_b32 v80, s84, v17
    v_lshlrev_b32 v79, 16, v17
    s_cmp_lg_u32 s99, 0x80000000
    s_cbranch_scc1 L_void_2a
    v_mov_b32 v17, 0xff80ff80
    s_branch L_void_2b
L_void_2a:
    v_max3_f32 v81, v81, v79, v80
L_void_2b:
    v_mov_b32 v79, v81
    s_nop 1
    v_permlane32_swap_b32 v81, v79
    v_max_f32 v81, v81, v79
    v_mov_b32 v79, v81
    s_nop 1
    v_permlane16_swap_b32 v81, v79
    v_max_f32 v81, v81, v79
    v_mul_f32 v82, s85, v81
    v_mov_b32 v83, 0
    v_mov_b32 v20, 0
    v_mov_b32 v21, 0
    v_mov_b32 v22, 0
    v_mov_b32 v23, 0
    v_mov_b32 v24, 0
    v_mov_b32 v25, 0
    v_mov_b32 v26, 0
    v_mov_b32 v27, 0
    v_mov_b32 v28, 0
    v_mov_b32 v29, 0
    v_mov_b32 v30, 0
    v_mov_b32 v31, 0
    v_mov_b32 v32, 0
    v_mov_b32 v33, 0
    v_mov_b32 v34, 0
    v_mov_b32 v35, 0
    v_mov_b32 v36, 0
    v_mov_b32 v37, 0
    v_mov_b32 v38, 0
    v_mov_b32 v39, 0
    v_mov_b32 v40, 0
    v_mov_b32 v41, 0
    v_mov_b32 v42, 0
    v_mov_b32 v43, 0
    s_waitcnt vmcnt(4)
    buffer_load_dwordx4 v[88:91], v2, s[36:39], s83 offen offset:512 nt
    s_waitcnt vmcnt(4)
    s_add_u32 s83, s30, 6144
    s_sub_u32 s87, s83, 36864
    s_cmp_ge_u32 s83, s31
    s_cselect_b32 s83, s87, s83
    buffer_load_dwordx4 v[96:99], v2, s[36:39], s83 offen offset:0 nt
    s_waitcnt vmcnt(4)
    buffer_load_dwordx4 v[100:103], v2, s[36:39], s83 offen offset:256 nt
    v_lshlrev_b32 v76, 16, v4
    v_and_b32 v77, s84, v4
    v_fma_f32 v76, v76, s85, -v82
    v_fma_f32 v77, v77, s85, -v82
    v_exp_f32 v76, v76
    v_exp_f32 v77, v77
    s_nop 0
    v_cndmask_b32 v78, v77, v76, s[88:89]
    v_add_f32 v83, v83, v76
    v_add_f32 v83, v83, v77
    v_lshlrev_b32 v79, 16, v104
    v_and_b32 v80, s84, v104
    v_fmac_f32 v20, v76, v79
    v_fmac_f32 v21, v76, v80
    v_lshlrev_b32 v79, 16, v105
    v_and_b32 v80, s84, v105
    v_fmac_f32 v22, v76, v79
    v_fmac_f32 v23, v76, v80
    v_lshlrev_b32 v79, 16, v106
    v_and_b32 v80, s84, v106
    v_fmac_f32 v24, v76, v79
    v_fmac_f32 v25, v76, v80
    v_lshlrev_b32 v79, 16, v107
    v_and_b32 v80, s84, v107
    v_fmac_f32 v26, v76, v79
    v_fmac_f32 v27, v76, v80
    v_lshlrev_b32 v79, 16, v108
    v_and_b32 v80, s84, v108
    v_fmac_f32 v28, v78, v79
    v_fmac_f32 v29, v78, v80
    v_lshlrev_b32 v79, 16, v109
    v_and_b32 v80, s84, v109
    v_fmac_f32 v30, v78, v79
    v_fmac_f32 v31, v78, v80
    v_lshlrev_b32 v79, 16, v110
    v_and_b32 v80, s84, v110
    v_fmac_f32 v32, v78, v79
    v_fmac_f32 v33, v78, v80
    v_lshlrev_b32 v79, 16, v111
    v_and_b32 v80, s84, v111
    v_fmac_f32 v34, v78, v79
    v_fmac_f32 v35, v78, v80
    v_lshlrev_b32 v79, 16, v92
    v_and_b32 v80, s84, v92
    v_fmac_f32 v36, v77, v79
    v_fmac_f32 v37, v77, v80
    v_lshlrev_b32 v79, 16, v93
    v_and_b32 v80, s84, v93
    v_fmac_f32 v38, v77, v79
    v_fmac_f32 v39, v77, v80
    v_lshlrev_b32 v79, 16, v94
    v_and_b32 v80, s84, v94
    v_fmac_f32 v40, v77, v79
    v_fmac_f32 v41, v77, v80
    v_lshlrev_b32 v79, 16, v95
    v_and_b32 v80, s84, v95
    v_fmac_f32 v42, v77, v79
    v_fmac_f32 v43, v77, v80
    s_waitcnt vmcnt(4)
    buffer_load_dwordx4 v[92:95], v2, s[36:39], s83 offen offset:512 nt
    s_waitcnt vmcnt(4)
    s_add_u32 s83, s30, 9216
    s_sub_u32 s87, s83, 36864
    s_cmp_ge_u32 s83, s31
    s_cselect_b32 s83, s87, s83
    buffer_load_dwordx4 v[104:107], v2, s[36:39], s83 offen offset:0 nt
    s_waitcnt vmcnt(4)
    buffer_load_dwordx4 v[108:111], v2, s[36:39], s83 offen offset:256 nt
    v_lshlrev_b32 v76, 16, v5
    v_and_b32 v77, s84, v5
    v_fma_f32 v76, v76, s85, -v82
    v_fma_f32 v77, v77, s85, -v82
    v_exp_f32 v76, v76
    v_exp_f32 v77, v77
    s_nop 0
    v_cndmask_b32 v78, v77, v76, s[88:89]
    v_add_f32 v83, v83, v76
    v_add_f32 v83, v83, v77
    v_lshlrev_b32 v79, 16, v112
    v_and_b32 v80, s84, v112
    v_fmac_f32 v20, v76, v79
    v_fmac_f32 v21, v76, v80
    v_lshlrev_b32 v79, 16, v113
    v_and_b32 v80, s84, v113
    v_fmac_f32 v22, v76, v79
    v_fmac_f32 v23, v76, v80
    v_lshlrev_b32 v79, 16, v114
    v_and_b32 v80, s84, v114
    v_fmac_f32 v24, v76, v79
    v_fmac_f32 v25, v76, v80
    v_lshlrev_b32 v79, 16, v115
    v_and_b32 v80, s84, v115
    v_fmac_f32 v26, v76, v79
    v_fmac_f32 v27, v76, v80
    v_lshlrev_b32 v79, 16, v116
    v_and_b32 v80, s84, v116
    v_fmac_f32 v28, v78, v79
    v_fmac_f32 v29, v78, v80
    v_lshlrev_b32 v79, 16, v117
    v_and_b32 v80, s84, v117
    v_fmac_f32 v30, v78, v79
    v_fmac_f32 v31, v78, v80
    v_lshlrev_b32 v79, 16, v118
    v_and_b32 v80, s84, v118
    v_fmac_f32 v32, v78, v79
    v_fmac_f32 v33, v78, v80
    v_lshlrev_b32 v79, 16, v119
    v_and_b32 v80, s84, v119
    v_fmac_f32 v34, v78, v79
    v_fmac_f32 v35, v78, v80
    v_lshlrev_b32 v79, 16, v88
    v_and_b32 v80, s84, v88
    v_fmac_f32 v36, v77, v79
    v_fmac_f32 v37, v77, v80
    v_lshlrev_b32 v79, 16, v89
    v_and_b32 v80, s84, v89
    v_fmac_f32 v38, v77, v79
    v_fmac_f32 v39, v77, v80
    v_lshlrev_b32 v79, 16, v90
    v_and_b32 v80, s84, v90
    v_fmac_f32 v40, v77, v79
    v_fmac_f32 v41, v77, v80
    v_lshlrev_b32 v79, 16, v91
    v_and_b32 v80, s84, v91
    v_fmac_f32 v42, v77, v79
    v_fmac_f32 v43, v77, v80
    s_waitcnt vmcnt(4)
    buffer_load_dwordx4 v[88:91], v2, s[36:39], s83 offen offset:512 nt
    s_waitcnt vmcnt(4)
    s_add_u32 s83, s30, 12288
    s_sub_u32 s87, s83, 36864
    s_cmp_ge_u32 s83, s31
    s_cselect_b32 s83, s87, s83
    buffer_load_dwordx4 v[112:115], v2, s[36:39], s83 offen offset:0 nt
    s_waitcnt vmcnt(4)
    buffer_load_dwordx4 v[116:119], v2, s[36:39], s83 offen offset:256 nt
    v_lshlrev_b32 v76, 16, v6
    v_and_b32 v77, s84, v6
    v_fma_f32 v76, v76, s85, -v82
    v_fma_f32 v77, v77, s85, -v82
    v_exp_f32 v76, v76
    v_exp_f32 v77, v77
    s_nop 0
    v_cndmask_b32 v78, v77, v76, s[88:89]
    v_add_f32 v83, v83, v76
    v_add_f32 v83, v83, v77
    v_lshlrev_b32 v79, 16, v96
    v_and_b32 v80, s84, v96
    v_fmac_f32 v20, v76, v79
    v_fmac_f32 v21, v76, v80
    v_lshlrev_b32 v79, 16, v97
    v_and_b32 v80, s84, v97
    v_fmac_f32 v22, v76, v79
    v_fmac_f32 v23, v76, v80
    v_lshlrev_b32 v79, 16, v98
    v_and_b32 v80, s84, v98
    v_fmac_f32 v24, v76, v79
    v_fmac_f32 v25, v76, v80
    v_lshlrev_b32 v79, 16, v99
    v_and_b32 v80, s84, v99
    v_fmac_f32 v26, v76, v79
    v_fmac_f32 v27, v76, v80
    v_lshlrev_b32 v79, 16, v100
    v_and_b32 v80, s84, v100
    v_fmac_f32 v28, v78, v79
    v_fmac_f32 v29, v78, v80
    v_lshlrev_b32 v79, 16, v101
    v_and_b32 v80, s84, v101
    v_fmac_f32 v30, v78, v79
    v_fmac_f32 v31, v78, v80
    v_lshlrev_b32 v79, 16, v102
    v_and_b32 v80, s84, v102
    v_fmac_f32 v32, v78, v79
    v_fmac_f32 v33, v78, v80
    v_lshlrev_b32 v79, 16, v103
    v_and_b32 v80, s84, v103
    v_fmac_f32 v34, v78, v79
    v_fmac_f32 v35, v78, v80
    v_lshlrev_b32 v79, 16, v92
    v_and_b32 v80, s84, v92
    v_fmac_f32 v36, v77, v79
    v_fmac_f32 v37, v77, v80
    v_lshlrev_b32 v79, 16, v93
    v_and_b32 v80, s84, v93
    v_fmac_f32 v38, v77, v79
    v_fmac_f32 v39, v77, v80
    v_lshlrev_b32 v79, 16, v94
    v_and_b32 v80, s84, v94
    v_fmac_f32 v40, v77, v79
    v_fmac_f32 v41, v77, v80
    v_lshlrev_b32 v79, 16, v95
    v_and_b32 v80, s84, v95
    v_fmac_f32 v42, v77, v79
    v_fmac_f32 v43, v77, v80
    s_waitcnt vmcnt(4)
    buffer_load_dwordx4 v[92:95], v2, s[36:39], s83 offen offset:512 nt
    s_waitcnt vmcnt(4)
    s_add_u32 s83, s30, 15360
    s_sub_u32 s87, s83, 36864
    s_cmp_ge_u32 s83, s31
    s_cselect_b32 s83, s87, s83
    buffer_load_dwordx4 v[96:99], v2, s[36:39], s83 offen offset:0 nt
    s_waitcnt vmcnt(4)
    buffer_load_dwordx4 v[100:103], v2, s[36:39], s83 offen offset:256 nt
    v_lshlrev_b32 v76, 16, v7
    v_and_b32 v77, s84, v7
    v_fma_f32 v76, v76, s85, -v82
    v_fma_f32 v77, v77, s85, -v82
    v_exp_f32 v76, v76
    v_exp_f32 v77, v77
    s_nop 0
    v_cndmask_b32 v78, v77, v76, s[88:89]
    v_add_f32 v83, v83, v76
    v_add_f32 v83, v83, v77
    v_lshlrev_b32 v79, 16, v104
    v_and_b32 v80, s84, v104
    v_fmac_f32 v20, v76, v79
    v_fmac_f32 v21, v76, v80
    v_lshlrev_b32 v79, 16, v105
    v_and_b32 v80, s84, v105
    v_fmac_f32 v22, v76, v79
    v_fmac_f32 v23, v76, v80
    v_lshlrev_b32 v79, 16, v106
    v_and_b32 v80, s84, v106
    v_fmac_f32 v24, v76, v79
    v_fmac_f32 v25, v76, v80
    v_lshlrev_b32 v79, 16, v107
    v_and_b32 v80, s84, v107
    v_fmac_f32 v26, v76, v79
    v_fmac_f32 v27, v76, v80
    v_lshlrev_b32 v79, 16, v108
    v_and_b32 v80, s84, v108
    v_fmac_f32 v28, v78, v79
    v_fmac_f32 v29, v78, v80
    v_lshlrev_b32 v79, 16, v109
    v_and_b32 v80, s84, v109
    v_fmac_f32 v30, v78, v79
    v_fmac_f32 v31, v78, v80
    v_lshlrev_b32 v79, 16, v110
    v_and_b32 v80, s84, v110
    v_fmac_f32 v32, v78, v79
    v_fmac_f32 v33, v78, v80
    v_lshlrev_b32 v79, 16, v111
    v_and_b32 v80, s84, v111
    v_fmac_f32 v34, v78, v79
    v_fmac_f32 v35, v78, v80
    v_lshlrev_b32 v79, 16, v88
    v_and_b32 v80, s84, v88
    v_fmac_f32 v36, v77, v79
    v_fmac_f32 v37, v77, v80
    v_lshlrev_b32 v79, 16, v89
    v_and_b32 v80, s84, v89
    v_fmac_f32 v38, v77, v79
    v_fmac_f32 v39, v77, v80
    v_lshlrev_b32 v79, 16, v90
    v_and_b32 v80, s84, v90
    v_fmac_f32 v40, v77, v79
    v_fmac_f32 v41, v77, v80
    v_lshlrev_b32 v79, 16, v91
    v_and_b32 v80, s84, v91
    v_fmac_f32 v42, v77, v79
    v_fmac_f32 v43, v77, v80
    s_waitcnt vmcnt(4)
    buffer_load_dwordx4 v[88:91], v2, s[36:39], s83 offen offset:512 nt
    s_waitcnt vmcnt(4)
    s_add_u32 s83, s30, 18432
    s_sub_u32 s87, s83, 36864
    s_cmp_ge_u32 s83, s31
    s_cselect_b32 s83, s87, s83
    buffer_load_dwordx4 v[104:107], v2, s[36:39], s83 offen offset:0 nt
    s_waitcnt vmcnt(4)
    buffer_load_dwordx4 v[108:111], v2, s[36:39], s83 offen offset:256 nt
    v_lshlrev_b32 v76, 16, v8
    v_and_b32 v77, s84, v8
    v_fma_f32 v76, v76, s85, -v82
    v_fma_f32 v77, v77, s85, -v82
    v_exp_f32 v76, v76
    v_exp_f32 v77, v77
    s_nop 0
    v_cndmask_b32 v78, v77, v76, s[88:89]
    v_add_f32 v83, v83, v76
    v_add_f32 v83, v83, v77
    v_lshlrev_b32 v79, 16, v112
    v_and_b32 v80, s84, v112
    v_fmac_f32 v20, v76, v79
    v_fmac_f32 v21, v76, v80
    v_lshlrev_b32 v79, 16, v113
    v_and_b32 v80, s84, v113
    v_fmac_f32 v22, v76, v79
    v_fmac_f32 v23, v76, v80
    v_lshlrev_b32 v79, 16, v114
    v_and_b32 v80, s84, v114
    v_fmac_f32 v24, v76, v79
    v_fmac_f32 v25, v76, v80
    v_lshlrev_b32 v79, 16, v115
    v_and_b32 v80, s84, v115
    v_fmac_f32 v26, v76, v79
    v_fmac_f32 v27, v76, v80
    v_lshlrev_b32 v79, 16, v116
    v_and_b32 v80, s84, v116
    v_fmac_f32 v28, v78, v79
    v_fmac_f32 v29, v78, v80
    v_lshlrev_b32 v79, 16, v117
    v_and_b32 v80, s84, v117
    v_fmac_f32 v30, v78, v79
    v_fmac_f32 v31, v78, v80
    v_lshlrev_b32 v79, 16, v118
    v_and_b32 v80, s84, v118
    v_fmac_f32 v32, v78, v79
    v_fmac_f32 v33, v78, v80
    v_lshlrev_b32 v79, 16, v119
    v_and_b32 v80, s84, v119
    v_fmac_f32 v34, v78, v79
    v_fmac_f32 v35, v78, v80
    v_lshlrev_b32 v79, 16, v92
    v_and_b32 v80, s84, v92
    v_fmac_f32 v36, v77, v79
    v_fmac_f32 v37, v77, v80
    v_lshlrev_b32 v79, 16, v93
    v_and_b32 v80, s84, v93
    v_fmac_f32 v38, v77, v79
    v_fmac_f32 v39, v77, v80
    v_lshlrev_b32 v79, 16, v94
    v_and_b32 v80, s84, v94
    v_fmac_f32 v40, v77, v79
    v_fmac_f32 v41, v77, v80
    v_lshlrev_b32 v79, 16, v95
    v_and_b32 v80, s84, v95
    v_fmac_f32 v42, v77, v79
    v_fmac_f32 v43, v77, v80
    s_waitcnt vmcnt(4)
    buffer_load_dwordx4 v[92:95], v2, s[36:39], s83 offen offset:512 nt
    s_waitcnt vmcnt(4)
    s_add_u32 s83, s30, 21504
    s_sub_u32 s87, s83, 36864
    s_cmp_ge_u32 s83, s31
    s_cselect_b32 s83, s87, s83
    buffer_load_dwordx4 v[112:115], v2, s[36:39], s83 offen offset:0 nt
    s_waitcnt vmcnt(4)
    buffer_load_dwordx4 v[116:119], v2, s[36:39], s83 offen offset:256 nt
    v_lshlrev_b32 v76, 16, v9
    v_and_b32 v77, s84, v9
    v_fma_f32 v76, v76, s85, -v82
    v_fma_f32 v77, v77, s85, -v82
    v_exp_f32 v76, v76
    v_exp_f32 v77, v77
    s_nop 0
    v_cndmask_b32 v78, v77, v76, s[88:89]
    v_add_f32 v83, v83, v76
    v_add_f32 v83, v83, v77
    v_lshlrev_b32 v79, 16, v96
    v_and_b32 v80, s84, v96
    v_fmac_f32 v20, v76, v79
    v_fmac_f32 v21, v76, v80
    v_lshlrev_b32 v79, 16, v97
    v_and_b32 v80, s84, v97
    v_fmac_f32 v22, v76, v79
    v_fmac_f32 v23, v76, v80
    v_lshlrev_b32 v79, 16, v98
    v_and_b32 v80, s84, v98
    v_fmac_f32 v24, v76, v79
    v_fmac_f32 v25, v76, v80
    v_lshlrev_b32 v79, 16, v99
    v_and_b32 v80, s84, v99
    v_fmac_f32 v26, v76, v79
    v_fmac_f32 v27, v76, v80
    v_lshlrev_b32 v79, 16, v100
    v_and_b32 v80, s84, v100
    v_fmac_f32 v28, v78, v79
    v_fmac_f32 v29, v78, v80
    v_lshlrev_b32 v79, 16, v101
    v_and_b32 v80, s84, v101
    v_fmac_f32 v30, v78, v79
    v_fmac_f32 v31, v78, v80
    v_lshlrev_b32 v79, 16, v102
    v_and_b32 v80, s84, v102
    v_fmac_f32 v32, v78, v79
    v_fmac_f32 v33, v78, v80
    v_lshlrev_b32 v79, 16, v103
    v_and_b32 v80, s84, v103
    v_fmac_f32 v34, v78, v79
    v_fmac_f32 v35, v78, v80
    v_lshlrev_b32 v79, 16, v88
    v_and_b32 v80, s84, v88
    v_fmac_f32 v36, v77, v79
    v_fmac_f32 v37, v77, v80
    v_lshlrev_b32 v79, 16, v89
    v_and_b32 v80, s84, v89
    v_fmac_f32 v38, v77, v79
    v_fmac_f32 v39, v77, v80
    v_lshlrev_b32 v79, 16, v90
    v_and_b32 v80, s84, v90
    v_fmac_f32 v40, v77, v79
    v_fmac_f32 v41, v77, v80
    v_lshlrev_b32 v79, 16, v91
    v_and_b32 v80, s84, v91
    v_fmac_f32 v42, v77, v79
    v_fmac_f32 v43, v77, v80
    s_waitcnt vmcnt(4)
    buffer_load_dwordx4 v[88:91], v2, s[36:39], s83 offen offset:512 nt
    s_waitcnt vmcnt(4)
    s_add_u32 s83, s30, 24576
    s_sub_u32 s87, s83, 36864
    s_cmp_ge_u32 s83, s31
    s_cselect_b32 s83, s87, s83
    buffer_load_dwordx4 v[96:99], v2, s[36:39], s83 offen offset:0 nt
    s_waitcnt vmcnt(4)
    buffer_load_dwordx4 v[100:103], v2, s[36:39], s83 offen offset:256 nt
    v_lshlrev_b32 v76, 16, v10
    v_and_b32 v77, s84, v10
    v_fma_f32 v76, v76, s85, -v82
    v_fma_f32 v77, v77, s85, -v82
    v_exp_f32 v76, v76
    v_exp_f32 v77, v77
    s_nop 0
    v_cndmask_b32 v78, v77, v76, s[88:89]
    v_add_f32 v83, v83, v76
    v_add_f32 v83, v83, v77
    v_lshlrev_b32 v79, 16, v104
    v_and_b32 v80, s84, v104
    v_fmac_f32 v20, v76, v79
    v_fmac_f32 v21, v76, v80
    v_lshlrev_b32 v79, 16, v105
    v_and_b32 v80, s84, v105
    v_fmac_f32 v22, v76, v79
    v_fmac_f32 v23, v76, v80
    v_lshlrev_b32 v79, 16, v106
    v_and_b32 v80, s84, v106
    v_fmac_f32 v24, v76, v79
    v_fmac_f32 v25, v76, v80
    v_lshlrev_b32 v79, 16, v107
    v_and_b32 v80, s84, v107
    v_fmac_f32 v26, v76, v79
    v_fmac_f32 v27, v76, v80
    v_lshlrev_b32 v79, 16, v108
    v_and_b32 v80, s84, v108
    v_fmac_f32 v28, v78, v79
    v_fmac_f32 v29, v78, v80
    v_lshlrev_b32 v79, 16, v109
    v_and_b32 v80, s84, v109
    v_fmac_f32 v30, v78, v79
    v_fmac_f32 v31, v78, v80
    v_lshlrev_b32 v79, 16, v110
    v_and_b32 v80, s84, v110
    v_fmac_f32 v32, v78, v79
    v_fmac_f32 v33, v78, v80
    v_lshlrev_b32 v79, 16, v111
    v_and_b32 v80, s84, v111
    v_fmac_f32 v34, v78, v79
    v_fmac_f32 v35, v78, v80
    v_lshlrev_b32 v79, 16, v92
    v_and_b32 v80, s84, v92
    v_fmac_f32 v36, v77, v79
    v_fmac_f32 v37, v77, v80
    v_lshlrev_b32 v79, 16, v93
    v_and_b32 v80, s84, v93
    v_fmac_f32 v38, v77, v79
    v_fmac_f32 v39, v77, v80
    v_lshlrev_b32 v79, 16, v94
    v_and_b32 v80, s84, v94
    v_fmac_f32 v40, v77, v79
    v_fmac_f32 v41, v77, v80
    v_lshlrev_b32 v79, 16, v95
    v_and_b32 v80, s84, v95
    v_fmac_f32 v42, v77, v79
    v_fmac_f32 v43, v77, v80
    s_waitcnt vmcnt(4)
    buffer_load_dwordx4 v[92:95], v2, s[36:39], s83 offen offset:512 nt
    s_waitcnt vmcnt(4)
    s_add_u32 s83, s30, 27648
    s_sub_u32 s87, s83, 36864
    s_cmp_ge_u32 s83, s31
    s_cselect_b32 s83, s87, s83
    buffer_load_dwordx4 v[104:107], v2, s[36:39], s83 offen offset:0 nt
    s_waitcnt vmcnt(4)
    buffer_load_dwordx4 v[108:111], v2, s[36:39], s83 offen offset:256 nt
    v_lshlrev_b32 v76, 16, v11
    v_and_b32 v77, s84, v11
    v_fma_f32 v76, v76, s85, -v82
    v_fma_f32 v77, v77, s85, -v82
    v_exp_f32 v76, v76
    v_exp_f32 v77, v77
    s_nop 0
    v_cndmask_b32 v78, v77, v76, s[88:89]
    v_add_f32 v83, v83, v76
    v_add_f32 v83, v83, v77
    v_lshlrev_b32 v79, 16, v112
    v_and_b32 v80, s84, v112
    v_fmac_f32 v20, v76, v79
    v_fmac_f32 v21, v76, v80
    v_lshlrev_b32 v79, 16, v113
    v_and_b32 v80, s84, v113
    v_fmac_f32 v22, v76, v79
    v_fmac_f32 v23, v76, v80
    v_lshlrev_b32 v79, 16, v114
    v_and_b32 v80, s84, v114
    v_fmac_f32 v24, v76, v79
    v_fmac_f32 v25, v76, v80
    v_lshlrev_b32 v79, 16, v115
    v_and_b32 v80, s84, v115
    v_fmac_f32 v26, v76, v79
    v_fmac_f32 v27, v76, v80
    v_lshlrev_b32 v79, 16, v116
    v_and_b32 v80, s84, v116
    v_fmac_f32 v28, v78, v79
    v_fmac_f32 v29, v78, v80
    v_lshlrev_b32 v79, 16, v117
    v_and_b32 v80, s84, v117
    v_fmac_f32 v30, v78, v79
    v_fmac_f32 v31, v78, v80
    v_lshlrev_b32 v79, 16, v118
    v_and_b32 v80, s84, v118
    v_fmac_f32 v32, v78, v79
    v_fmac_f32 v33, v78, v80
    v_lshlrev_b32 v79, 16, v119
    v_and_b32 v80, s84, v119
    v_fmac_f32 v34, v78, v79
    v_fmac_f32 v35, v78, v80
    v_lshlrev_b32 v79, 16, v88
    v_and_b32 v80, s84, v88
    v_fmac_f32 v36, v77, v79
    v_fmac_f32 v37, v77, v80
    v_lshlrev_b32 v79, 16, v89
    v_and_b32 v80, s84, v89
    v_fmac_f32 v38, v77, v79
    v_fmac_f32 v39, v77, v80
    v_lshlrev_b32 v79, 16, v90
    v_and_b32 v80, s84, v90
    v_fmac_f32 v40, v77, v79
    v_fmac_f32 v41, v77, v80
    v_lshlrev_b32 v79, 16, v91
    v_and_b32 v80, s84, v91
    v_fmac_f32 v42, v77, v79
    v_fmac_f32 v43, v77, v80
    s_waitcnt vmcnt(4)
    buffer_load_dwordx4 v[88:91], v2, s[36:39], s83 offen offset:512 nt
    s_waitcnt vmcnt(4)
    s_mov_b32 s83, 0
    buffer_load_dwordx4 v[164:167], v84, s[44:47], s83 offen nt
    s_waitcnt vmcnt(4)
    s_mov_b32 s83, 40960
    buffer_load_dwordx4 v[160:163], v84, s[44:47], s83 offen nt
    v_lshlrev_b32 v76, 16, v12
    v_and_b32 v77, s84, v12
    v_fma_f32 v76, v76, s85, -v82
    v_fma_f32 v77, v77, s85, -v82
    v_exp_f32 v76, v76
    v_exp_f32 v77, v77
    s_nop 0
    v_cndmask_b32 v78, v77, v76, s[88:89]
    v_add_f32 v83, v83, v76
    v_add_f32 v83, v83, v77
    v_lshlrev_b32 v79, 16, v96
    v_and_b32 v80, s84, v96
    v_fmac_f32 v20, v76, v79
    v_fmac_f32 v21, v76, v80
    v_lshlrev_b32 v79, 16, v97
    v_and_b32 v80, s84, v97
    v_fmac_f32 v22, v76, v79
    v_fmac_f32 v23, v76, v80
    v_lshlrev_b32 v79, 16, v98
    v_and_b32 v80, s84, v98
    v_fmac_f32 v24, v76, v79
    v_fmac_f32 v25, v76, v80
    v_lshlrev_b32 v79, 16, v99
    v_and_b32 v80, s84, v99
    v_fmac_f32 v26, v76, v79
    v_fmac_f32 v27, v76, v80
    v_lshlrev_b32 v79, 16, v100
    v_and_b32 v80, s84, v100
    v_fmac_f32 v28, v78, v79
    v_fmac_f32 v29, v78, v80
    v_lshlrev_b32 v79, 16, v101
    v_and_b32 v80, s84, v101
    v_fmac_f32 v30, v78, v79
    v_fmac_f32 v31, v78, v80
    v_lshlrev_b32 v79, 16, v102
    v_and_b32 v80, s84, v102
    v_fmac_f32 v32, v78, v79
    v_fmac_f32 v33, v78, v80
    v_lshlrev_b32 v79, 16, v103
    v_and_b32 v80, s84, v103
    v_fmac_f32 v34, v78, v79
    v_fmac_f32 v35, v78, v80
    v_lshlrev_b32 v79, 16, v92
    v_and_b32 v80, s84, v92
    v_fmac_f32 v36, v77, v79
    v_fmac_f32 v37, v77, v80
    v_lshlrev_b32 v79, 16, v93
    v_and_b32 v80, s84, v93
    v_fmac_f32 v38, v77, v79
    v_fmac_f32 v39, v77, v80
    v_lshlrev_b32 v79, 16, v94
    v_and_b32 v80, s84, v94
    v_fmac_f32 v40, v77, v79
    v_fmac_f32 v41, v77, v80
    v_lshlrev_b32 v79, 16, v95
    v_and_b32 v80, s84, v95
    v_fmac_f32 v42, v77, v79
    v_fmac_f32 v43, v77, v80
    s_waitcnt vmcnt(4)
    s_mov_b32 s83, 81920
    buffer_load_dwordx4 v[156:159], v84, s[44:47], s83 offen nt
    s_waitcnt vmcnt(4)
    s_mov_b32 s83, 122880
    buffer_load_dwordx4 v[152:155], v84, s[44:47], s83 offen nt
    s_waitcnt vmcnt(4)
    s_mov_b32 s83, 163840
    buffer_load_dwordx4 v[148:151], v84, s[44:47], s83 offen nt
    v_lshlrev_b32 v76, 16, v13
    v_and_b32 v77, s84, v13
    v_fma_f32 v76, v76, s85, -v82
    v_fma_f32 v77, v77, s85, -v82
    v_exp_f32 v76, v76
    v_exp_f32 v77, v77
    s_nop 0
    v_cndmask_b32 v78, v77, v76, s[88:89]
    v_add_f32 v83, v83, v76
    v_add_f32 v83, v83, v77
    v_lshlrev_b32 v79, 16, v104
    v_and_b32 v80, s84, v104
    v_fmac_f32 v20, v76, v79
    v_fmac_f32 v21, v76, v80
    v_lshlrev_b32 v79, 16, v105
    v_and_b32 v80, s84, v105
    v_fmac_f32 v22, v76, v79
    v_fmac_f32 v23, v76, v80
    v_lshlrev_b32 v79, 16, v106
    v_and_b32 v80, s84, v106
    v_fmac_f32 v24, v76, v79
    v_fmac_f32 v25, v76, v80
    v_lshlrev_b32 v79, 16, v107
    v_and_b32 v80, s84, v107
    v_fmac_f32 v26, v76, v79
    v_fmac_f32 v27, v76, v80
    v_lshlrev_b32 v79, 16, v108
    v_and_b32 v80, s84, v108
    v_fmac_f32 v28, v78, v79
    v_fmac_f32 v29, v78, v80
    v_lshlrev_b32 v79, 16, v109
    v_and_b32 v80, s84, v109
    v_fmac_f32 v30, v78, v79
    v_fmac_f32 v31, v78, v80
    v_lshlrev_b32 v79, 16, v110
    v_and_b32 v80, s84, v110
    v_fmac_f32 v32, v78, v79
    v_fmac_f32 v33, v78, v80
    v_lshlrev_b32 v79, 16, v111
    v_and_b32 v80, s84, v111
    v_fmac_f32 v34, v78, v79
    v_fmac_f32 v35, v78, v80
    v_lshlrev_b32 v79, 16, v88
    v_and_b32 v80, s84, v88
    v_fmac_f32 v36, v77, v79
    v_fmac_f32 v37, v77, v80
    v_lshlrev_b32 v79, 16, v89
    v_and_b32 v80, s84, v89
    v_fmac_f32 v38, v77, v79
    v_fmac_f32 v39, v77, v80
    v_lshlrev_b32 v79, 16, v90
    v_and_b32 v80, s84, v90
    v_fmac_f32 v40, v77, v79
    v_fmac_f32 v41, v77, v80
    v_lshlrev_b32 v79, 16, v91
    v_and_b32 v80, s84, v91
    v_fmac_f32 v42, v77, v79
    v_fmac_f32 v43, v77, v80
    s_waitcnt vmcnt(4)
    s_mov_b32 s83, 204800
    buffer_load_dwordx4 v[144:147], v84, s[44:47], s83 offen nt
    s_waitcnt vmcnt(4)
    s_mov_b32 s83, 0
    buffer_load_dwordx4 v[140:143], v85, s[56:59], s83 offen nt
    s_waitcnt vmcnt(4)
    s_mov_b32 s83, 40960
    buffer_load_dwordx4 v[136:139], v85, s[56:59], s83 offen nt
    s_waitcnt vmcnt(4)
    s_add_u32 s83, s30, 30720
    s_sub_u32 s87, s83, 36864
    s_cmp_ge_u32 s83, s31
    s_cselect_b32 s83, s87, s83
    buffer_load_dwordx4 v[88:91], v2, s[36:39], s83 offen offset:0 nt
    s_waitcnt vmcnt(4)
    buffer_load_dwordx4 v[92:95], v2, s[36:39], s83 offen offset:256 nt
    s_waitcnt vmcnt(4)
    buffer_load_dwordx4 v[96:99], v2, s[36:39], s83 offen offset:512 nt
    s_waitcnt vmcnt(4)
    s_add_u32 s83, s30, 33792
    s_sub_u32 s87, s83, 36864
    s_cmp_ge_u32 s83, s31
    s_cselect_b32 s83, s87, s83
    buffer_load_dwordx4 v[100:103], v2, s[36:39], s83 offen offset:0 nt
    s_waitcnt vmcnt(4)
    buffer_load_dwordx4 v[104:107], v2, s[36:39], s83 offen offset:256 nt
    s_waitcnt vmcnt(4)
    buffer_load_dwordx4 v[108:111], v2, s[36:39], s83 offen offset:512 nt
    s_waitcnt vmcnt(4)
    s_add_u32 s83, s98, 36864
    buffer_load_dwordx4 v[112:115], v2, s[36:39], s83 offen offset:0 nt
    s_waitcnt vmcnt(4)
    s_add_u32 s83, s98, 36864
    buffer_load_dwordx4 v[116:119], v2, s[36:39], s83 offen offset:256 nt
    v_lshlrev_b32 v76, 16, v14
    v_and_b32 v77, s84, v14
    v_fma_f32 v76, v76, s85, -v82
    v_fma_f32 v77, v77, s85, -v82
    v_exp_f32 v76, v76
    v_exp_f32 v77, v77
    s_nop 0
    v_cndmask_b32 v78, v77, v76, s[88:89]
    v_add_f32 v83, v83, v76
    v_add_f32 v83, v83, v77
    v_lshlrev_b32 v79, 16, v88
    v_and_b32 v80, s84, v88
    v_fmac_f32 v20, v76, v79
    v_fmac_f32 v21, v76, v80
    v_lshlrev_b32 v79, 16, v89
    v_and_b32 v80, s84, v89
    v_fmac_f32 v22, v76, v79
    v_fmac_f32 v23, v76, v80
    v_lshlrev_b32 v79, 16, v90
    v_and_b32 v80, s84, v90
    v_fmac_f32 v24, v76, v79
    v_fmac_f32 v25, v76, v80
    v_lshlrev_b32 v79, 16, v91
    v_and_b32 v80, s84, v91
    v_fmac_f32 v26, v76, v79
    v_fmac_f32 v27, v76, v80
    v_lshlrev_b32 v79, 16, v92
    v_and_b32 v80, s84, v92
    v_fmac_f32 v28, v78, v79
    v_fmac_f32 v29, v78, v80
    v_lshlrev_b32 v79, 16, v93
    v_and_b32 v80, s84, v93
    v_fmac_f32 v30, v78, v79
    v_fmac_f32 v31, v78, v80
    v_lshlrev_b32 v79, 16, v94
    v_and_b32 v80, s84, v94
    v_fmac_f32 v32, v78, v79
    v_fmac_f32 v33, v78, v80
    v_lshlrev_b32 v79, 16, v95
    v_and_b32 v80, s84, v95
    v_fmac_f32 v34, v78, v79
    v_fmac_f32 v35, v78, v80
    v_lshlrev_b32 v79, 16, v96
    v_and_b32 v80, s84, v96
    v_fmac_f32 v36, v77, v79
    v_fmac_f32 v37, v77, v80
    v_lshlrev_b32 v79, 16, v97
    v_and_b32 v80, s84, v97
    v_fmac_f32 v38, v77, v79
    v_fmac_f32 v39, v77, v80
    v_lshlrev_b32 v79, 16, v98
    v_and_b32 v80, s84, v98
    v_fmac_f32 v40, v77, v79
    v_fmac_f32 v41, v77, v80
    v_lshlrev_b32 v79, 16, v99
    v_and_b32 v80, s84, v99
    v_fmac_f32 v42, v77, v79
    v_fmac_f32 v43, v77, v80
    s_waitcnt vmcnt(4)
    s_add_u32 s83, s98, 36864
    buffer_load_dwordx4 v[88:91], v2, s[36:39], s83 offen offset:512 nt
    buffer_atomic_add v86, v87, s[76:79], 0 offen sc0
    s_waitcnt vmcnt(5)
    s_add_u32 s83, s99, 39936
    buffer_load_dwordx4 v[92:95], v2, s[36:39], s83 offen offset:0 nt
    s_waitcnt vmcnt(5)
    s_add_u32 s83, s99, 39936
    buffer_load_dwordx4 v[96:99], v2, s[36:39], s83 offen offset:256 nt
    v_lshlrev_b32 v76, 16, v15
    v_and_b32 v77, s84, v15
    v_fma_f32 v76, v76, s85, -v82
    v_fma_f32 v77, v77, s85, -v82
    v_exp_f32 v76, v76
    v_exp_f32 v77, v77
    s_nop 0
    v_cndmask_b32 v78, v77, v76, s[88:89]
    v_add_f32 v83, v83, v76
    v_add_f32 v83, v83, v77
    v_lshlrev_b32 v79, 16, v100
    v_and_b32 v80, s84, v100
    v_fmac_f32 v20, v76, v79
    v_fmac_f32 v21, v76, v80
    v_lshlrev_b32 v79, 16, v101
    v_and_b32 v80, s84, v101
    v_fmac_f32 v22, v76, v79
    v_fmac_f32 v23, v76, v80
    v_lshlrev_b32 v79, 16, v102
    v_and_b32 v80, s84, v102
    v_fmac_f32 v24, v76, v79
    v_fmac_f32 v25, v76, v80
    v_lshlrev_b32 v79, 16, v103
    v_and_b32 v80, s84, v103
    v_fmac_f32 v26, v76, v79
    v_fmac_f32 v27, v76, v80
    v_lshlrev_b32 v79, 16, v104
    v_and_b32 v80, s84, v104
    v_fmac_f32 v28, v78, v79
    v_fmac_f32 v29, v78, v80
    v_lshlrev_b32 v79, 16, v105
    v_and_b32 v80, s84, v105
    v_fmac_f32 v30, v78, v79
    v_fmac_f32 v31, v78, v80
    v_lshlrev_b32 v79, 16, v106
    v_and_b32 v80, s84, v106
    v_fmac_f32 v32, v78, v79
    v_fmac_f32 v33, v78, v80
    v_lshlrev_b32 v79, 16, v107
    v_and_b32 v80, s84, v107
    v_fmac_f32 v34, v78, v79
    v_fmac_f32 v35, v78, v80
    v_lshlrev_b32 v79, 16, v108
    v_and_b32 v80, s84, v108
    v_fmac_f32 v36, v77, v79
    v_fmac_f32 v37, v77, v80
    v_lshlrev_b32 v79, 16, v109
    v_and_b32 v80, s84, v109
    v_fmac_f32 v38, v77, v79
    v_fmac_f32 v39, v77, v80
    v_lshlrev_b32 v79, 16, v110
    v_and_b32 v80, s84, v110
    v_fmac_f32 v40, v77, v79
    v_fmac_f32 v41, v77, v80
    v_lshlrev_b32 v79, 16, v111
    v_and_b32 v80, s84, v111
    v_fmac_f32 v42, v77, v79
    v_fmac_f32 v43, v77, v80
    s_waitcnt vmcnt(5)
    s_add_u32 s83, s99, 39936
    buffer_load_dwordx4 v[100:103], v2, s[36:39], s83 offen offset:512 nt
    s_waitcnt vmcnt(4)
    v_lshlrev_b32 v76, 16, v16
    v_and_b32 v77, s84, v16
    v_fma_f32 v76, v76, s85, -v82
    v_fma_f32 v77, v77, s85, -v82
    v_exp_f32 v76, v76
    v_exp_f32 v77, v77
    s_nop 0
    v_cndmask_b32 v78, v77, v76, s[88:89]
    v_add_f32 v83, v83, v76
    v_add_f32 v83, v83, v77
    v_lshlrev_b32 v79, 16, v112
    v_and_b32 v80, s84, v112
    v_fmac_f32 v20, v76, v79
    v_fmac_f32 v21, v76, v80
    v_lshlrev_b32 v79, 16, v113
    v_and_b32 v80, s84, v113
    v_fmac_f32 v22, v76, v79
    v_fmac_f32 v23, v76, v80
    v_lshlrev_b32 v79, 16, v114
    v_and_b32 v80, s84, v114
    v_fmac_f32 v24, v76, v79
    v_fmac_f32 v25, v76, v80
    v_lshlrev_b32 v79, 16, v115
    v_and_b32 v80, s84, v115
    v_fmac_f32 v26, v76, v79
    v_fmac_f32 v27, v76, v80
    v_lshlrev_b32 v79, 16, v116
    v_and_b32 v80, s84, v116
    v_fmac_f32 v28, v78, v79
    v_fmac_f32 v29, v78, v80
    v_lshlrev_b32 v79, 16, v117
    v_and_b32 v80, s84, v117
    v_fmac_f32 v30, v78, v79
    v_fmac_f32 v31, v78, v80
    v_lshlrev_b32 v79, 16, v118
    v_and_b32 v80, s84, v118
    v_fmac_f32 v32, v78, v79
    v_fmac_f32 v33, v78, v80
    v_lshlrev_b32 v79, 16, v119
    v_and_b32 v80, s84, v119
    v_fmac_f32 v34, v78, v79
    v_fmac_f32 v35, v78, v80
    v_lshlrev_b32 v79, 16, v88
    v_and_b32 v80, s84, v88
    v_fmac_f32 v36, v77, v79
    v_fmac_f32 v37, v77, v80
    v_lshlrev_b32 v79, 16, v89
    v_and_b32 v80, s84, v89
    v_fmac_f32 v38, v77, v79
    v_fmac_f32 v39, v77, v80
    v_lshlrev_b32 v79, 16, v90
    v_and_b32 v80, s84, v90
    v_fmac_f32 v40, v77, v79
    v_fmac_f32 v41, v77, v80
    v_lshlrev_b32 v79, 16, v91
    v_and_b32 v80, s84, v91
    v_fmac_f32 v42, v77, v79
    v_fmac_f32 v43, v77, v80
    s_waitcnt vmcnt(0)
    v_lshlrev_b32 v76, 16, v17
    v_and_b32 v77, s84, v17
    v_fma_f32 v76, v76, s85, -v82
    v_fma_f32 v77, v77, s85, -v82
    v_exp_f32 v76, v76
    v_exp_f32 v77, v77
    s_nop 0
    v_cndmask_b32 v78, v77, v76, s[88:89]
    v_add_f32 v83, v83, v76
    v_add_f32 v83, v83, v77
    v_lshlrev_b32 v79, 16, v92
    v_and_b32 v80, s84, v92
    v_fmac_f32 v20, v76, v79
    v_fmac_f32 v21, v76, v80
    v_lshlrev_b32 v79, 16, v93
    v_and_b32 v80, s84, v93
    v_fmac_f32 v22, v76, v79
    v_fmac_f32 v23, v76, v80
    v_lshlrev_b32 v79, 16, v94
    v_and_b32 v80, s84, v94
    v_fmac_f32 v24, v76, v79
    v_fmac_f32 v25, v76, v80
    v_lshlrev_b32 v79, 16, v95
    v_and_b32 v80, s84, v95
    v_fmac_f32 v26, v76, v79
    v_fmac_f32 v27, v76, v80
    v_lshlrev_b32 v79, 16, v96
    v_and_b32 v80, s84, v96
    v_fmac_f32 v28, v78, v79
    v_fmac_f32 v29, v78, v80
    v_lshlrev_b32 v79, 16, v97
    v_and_b32 v80, s84, v97
    v_fmac_f32 v30, v78, v79
    v_fmac_f32 v31, v78, v80
    v_lshlrev_b32 v79, 16, v98
    v_and_b32 v80, s84, v98
    v_fmac_f32 v32, v78, v79
    v_fmac_f32 v33, v78, v80
    v_lshlrev_b32 v79, 16, v99
    v_and_b32 v80, s84, v99
    v_fmac_f32 v34, v78, v79
    v_fmac_f32 v35, v78, v80
    v_lshlrev_b32 v79, 16, v100
    v_and_b32 v80, s84, v100
    v_fmac_f32 v36, v77, v79
    v_fmac_f32 v37, v77, v80
    v_lshlrev_b32 v79, 16, v101
    v_and_b32 v80, s84, v101
    v_fmac_f32 v38, v77, v79
    v_fmac_f32 v39, v77, v80
    v_lshlrev_b32 v79, 16, v102
    v_and_b32 v80, s84, v102
    v_fmac_f32 v40, v77, v79
    v_fmac_f32 v41, v77, v80
    v_lshlrev_b32 v79, 16, v103
    v_and_b32 v80, s84, v103
    v_fmac_f32 v42, v77, v79
    v_fmac_f32 v43, v77, v80
    s_waitcnt vmcnt(0)
    v_readfirstlane_b32 s30, v86
    v_mov_b32 v86, 1
    s_nop 2
    s_cmp_ge_u32 s30, 192
    s_cbranch_scc1 L_pool_done
    s_mul_i32 s83, s30, 3072
    s_add_u32 s83, s83, 2555904
    buffer_atomic_add v86, v87, s[76:79], 0 offen sc0
    buffer_load_dwordx4 v[88:91], v1, s[32:35], s83 offen offset:0 nt
    buffer_load_dwordx4 v[92:95], v1, s[32:35], s83 offen offset:256 nt
    buffer_load_dwordx4 v[96:99], v1, s[32:35], s83 offen offset:512 nt
    buffer_load_dwordx4 v[100:103], v2, s[36:39], s83 offen offset:0 nt
    buffer_load_dwordx4 v[104:107], v2, s[36:39], s83 offen offset:256 nt
    buffer_load_dwordx4 v[108:111], v2, s[36:39], s83 offen offset:512 nt
L_pool_loop:
    s_waitcnt vmcnt(3)
    v_mfma_f32_16x16x32_bf16 v[60:63], v[88:91], v[44:47], 0
    v_mfma_f32_16x16x32_bf16 v[64:67], v[92:95], v[52:55], 0
    v_mfma_f32_16x16x32_bf16 v[60:63], v[92:95], v[48:51], v[60:63]
    v_mfma_f32_16x16x32_bf16 v[64:67], v[96:99], v[56:59], v[64:67]
    s_nop 7
    v_mov_b32_dpp v76, v60 quad_perm:[0,0,0,0] row_mask:0xf bank_mask:0xf
    v_mov_b32_dpp v77, v64 quad_perm:[0,0,0,0] row_mask:0xf bank_mask:0xf
    v_add_f32_dpp v76, v61, v76 quad_perm:[1,1,1,1] row_mask:0xf bank_mask:0xf
    v_add_f32_dpp v77, v65, v77 quad_perm:[1,1,1,1] row_mask:0xf bank_mask:0xf
    v_add_f32_dpp v76, v62, v76 quad_perm:[2,2,2,2] row_mask:0xf bank_mask:0xf
    v_add_f32_dpp v77, v66, v77 quad_perm:[2,2,2,2] row_mask:0xf bank_mask:0xf
    v_add_f32_dpp v76, v63, v76 quad_perm:[3,3,3,3] row_mask:0xf bank_mask:0xf
    v_add_f32_dpp v77, v67, v77 quad_perm:[3,3,3,3] row_mask:0xf bank_mask:0xf
    v_cvt_pk_bf16_f32 v76, v76, v77
    v_and_b32 v77, s84, v76
    v_lshlrev_b32 v76, 16, v76
    v_mul_f32 v76, s86, v76
    v_mul_f32 v77, s86, v77
    v_cvt_pk_bf16_f32 v4, v76, v77
    v_and_b32 v77, s84, v4
    v_lshlrev_b32 v76, 16, v4
    v_max3_f32 v79, v81, v76, v77
    v_sub_f32 v80, v81, v79
    v_mul_f32 v80, s85, v80
    v_exp_f32 v80, v80
    v_mov_b32 v81, v79
    v_mul_f32 v82, s85, v79
    v_fma_f32 v76, v76, s85, -v82
    v_fma_f32 v77, v77, s85, -v82
    v_exp_f32 v76, v76
    v_exp_f32 v77, v77
    v_mul_f32 v83, v83, v80
    v_mul_f32 v20, v20, v80
    v_mul_f32 v21, v21, v80
    v_mul_f32 v22, v22, v80
    v_mul_f32 v23, v23, v80
    v_mul_f32 v24, v24, v80
    v_mul_f32 v25, v25, v80
    v_mul_f32 v26, v26, v80
    v_mul_f32 v27, v27, v80
    v_mul_f32 v28, v28, v80
    v_mul_f32 v29, v29, v80
    v_mul_f32 v30, v30, v80
    v_mul_f32 v31, v31, v80
    v_mul_f32 v32, v32, v80
    v_mul_f32 v33, v33, v80
    v_mul_f32 v34, v34, v80
    v_mul_f32 v35, v35, v80
    v_mul_f32 v36, v36, v80
    v_mul_f32 v37, v37, v80
    v_mul_f32 v38, v38, v80
    v_mul_f32 v39, v39, v80
    v_mul_f32 v40, v40, v80
    v_mul_f32 v41, v41, v80
    v_mul_f32 v42, v42, v80
    v_mul_f32 v43, v43, v80
    s_waitcnt vmcnt(3)
    v_readfirstlane_b32 s30, v86
    v_mov_b32 v86, 1
    s_nop 2
    s_cmp_ge_u32 s30, 192
    s_cbranch_scc1 L_pool_lastA
    s_mul_i32 s83, s30, 3072
    s_add_u32 s83, s83, 2555904
    buffer_atomic_add v86, v87, s[76:79], 0 offen sc0
    buffer_load_dwordx4 v[112:115], v1, s[32:35], s83 offen offset:0 nt
    buffer_load_dwordx4 v[116:119], v1, s[32:35], s83 offen offset:256 nt
    buffer_load_dwordx4 v[120:123], v1, s[32:35], s83 offen offset:512 nt
    buffer_load_dwordx4 v[124:127], v2, s[36:39], s83 offen offset:0 nt
    buffer_load_dwordx4 v[128:131], v2, s[36:39], s83 offen offset:256 nt
    buffer_load_dwordx4 v[132:135], v2, s[36:39], s83 offen offset:512 nt
    s_waitcnt vmcnt(7)
    v_cndmask_b32 v78, v77, v76, s[88:89]
    v_add_f32 v83, v83, v76
    v_add_f32 v83, v83, v77
    v_lshlrev_b32 v79, 16, v100
    v_and_b32 v80, s84, v100
    v_fmac_f32 v20, v76, v79
    v_fmac_f32 v21, v76, v80
    v_lshlrev_b32 v79, 16, v101
    v_and_b32 v80, s84, v101
    v_fmac_f32 v22, v76, v79
    v_fmac_f32 v23, v76, v80
    v_lshlrev_b32 v79, 16, v102
    v_and_b32 v80, s84, v102
    v_fmac_f32 v24, v76, v79
    v_fmac_f32 v25, v76, v80
    v_lshlrev_b32 v79, 16, v103
    v_and_b32 v80, s84, v103
    v_fmac_f32 v26, v76, v79
    v_fmac_f32 v27, v76, v80
    v_lshlrev_b32 v79, 16, v104
    v_and_b32 v80, s84, v104
    v_fmac_f32 v28, v78, v79
    v_fmac_f32 v29, v78, v80
    v_lshlrev_b32 v79, 16, v105
    v_and_b32 v80, s84, v105
    v_fmac_f32 v30, v78, v79
    v_fmac_f32 v31, v78, v80
    v_lshlrev_b32 v79, 16, v106
    v_and_b32 v80, s84, v106
    v_fmac_f32 v32, v78, v79
    v_fmac_f32 v33, v78, v80
    v_lshlrev_b32 v79, 16, v107
    v_and_b32 v80, s84, v107
    v_fmac_f32 v34, v78, v79
    v_fmac_f32 v35, v78, v80
    v_lshlrev_b32 v79, 16, v108
    v_and_b32 v80, s84, v108
    v_fmac_f32 v36, v77, v79
    v_fmac_f32 v37, v77, v80
    v_lshlrev_b32 v79, 16, v109
    v_and_b32 v80, s84, v109
    v_fmac_f32 v38, v77, v79
    v_fmac_f32 v39, v77, v80
    v_lshlrev_b32 v79, 16, v110
    v_and_b32 v80, s84, v110
    v_fmac_f32 v40, v77, v79
    v_fmac_f32 v41, v77, v80
    v_lshlrev_b32 v79, 16, v111
    v_and_b32 v80, s84, v111
    v_fmac_f32 v42, v77, v79
    v_fmac_f32 v43, v77, v80
    s_waitcnt vmcnt(3)
    v_mfma_f32_16x16x32_bf16 v[60:63], v[112:115], v[44:47], 0
    v_mfma_f32_16x16x32_bf16 v[64:67], v[116:119], v[52:55], 0
    v_mfma_f32_16x16x32_bf16 v[60:63], v[116:119], v[48:51], v[60:63]
    v_mfma_f32_16x16x32_bf16 v[64:67], v[120:123], v[56:59], v[64:67]
    s_nop 7
    v_mov_b32_dpp v76, v60 quad_perm:[0,0,0,0] row_mask:0xf bank_mask:0xf
    v_mov_b32_dpp v77, v64 quad_perm:[0,0,0,0] row_mask:0xf bank_mask:0xf
    v_add_f32_dpp v76, v61, v76 quad_perm:[1,1,1,1] row_mask:0xf bank_mask:0xf
    v_add_f32_dpp v77, v65, v77 quad_perm:[1,1,1,1] row_mask:0xf bank_mask:0xf
    v_add_f32_dpp v76, v62, v76 quad_perm:[2,2,2,2] row_mask:0xf bank_mask:0xf
    v_add_f32_dpp v77, v66, v77 quad_perm:[2,2,2,2] row_mask:0xf bank_mask:0xf
    v_add_f32_dpp v76, v63, v76 quad_perm:[3,3,3,3] row_mask:0xf bank_mask:0xf
    v_add_f32_dpp v77, v67, v77 quad_perm:[3,3,3,3] row_mask:0xf bank_mask:0xf
    v_cvt_pk_bf16_f32 v76, v76, v77
    v_and_b32 v77, s84, v76
    v_lshlrev_b32 v76, 16, v76
    v_mul_f32 v76, s86, v76
    v_mul_f32 v77, s86, v77
    v_cvt_pk_bf16_f32 v4, v76, v77
    v_and_b32 v77, s84, v4
    v_lshlrev_b32 v76, 16, v4
    v_max3_f32 v79, v81, v76, v77
    v_sub_f32 v80, v81, v79
    v_mul_f32 v80, s85, v80
    v_exp_f32 v80, v80
    v_mov_b32 v81, v79
    v_mul_f32 v82, s85, v79
    v_fma_f32 v76, v76, s85, -v82
    v_fma_f32 v77, v77, s85, -v82
    v_exp_f32 v76, v76
    v_exp_f32 v77, v77
    v_mul_f32 v83, v83, v80
    v_mul_f32 v20, v20, v80
    v_mul_f32 v21, v21, v80
    v_mul_f32 v22, v22, v80
    v_mul_f32 v23, v23, v80
    v_mul_f32 v24, v24, v80
    v_mul_f32 v25, v25, v80
    v_mul_f32 v26, v26, v80
    v_mul_f32 v27, v27, v80
    v_mul_f32 v28, v28, v80
    v_mul_f32 v29, v29, v80
    v_mul_f32 v30, v30, v80
    v_mul_f32 v31, v31, v80
    v_mul_f32 v32, v32, v80
    v_mul_f32 v33, v33, v80
    v_mul_f32 v34, v34, v80
    v_mul_f32 v35, v35, v80
    v_mul_f32 v36, v36, v80
    v_mul_f32 v37, v37, v80
    v_mul_f32 v38, v38, v80
    v_mul_f32 v39, v39, v80
    v_mul_f32 v40, v40, v80
    v_mul_f32 v41, v41, v80
    v_mul_f32 v42, v42, v80
    v_mul_f32 v43, v43, v80
    s_waitcnt vmcnt(3)
    v_readfirstlane_b32 s30, v86
    v_mov_b32 v86, 1
    s_nop 2
    s_cmp_ge_u32 s30, 192
    s_cbranch_scc1 L_pool_lastB
    s_mul_i32 s83, s30, 3072
    s_add_u32 s83, s83, 2555904
    buffer_atomic_add v86, v87, s[76:79], 0 offen sc0
    buffer_load_dwordx4 v[88:91], v1, s[32:35], s83 offen offset:0 nt
    buffer_load_dwordx4 v[92:95], v1, s[32:35], s83 offen offset:256 nt
    buffer_load_dwordx4 v[96:99], v1, s[32:35], s83 offen offset:512 nt
    buffer_load_dwordx4 v[100:103], v2, s[36:39], s83 offen offset:0 nt
    buffer_load_dwordx4 v[104:107], v2, s[36:39], s83 offen offset:256 nt
    buffer_load_dwordx4 v[108:111], v2, s[36:39], s83 offen offset:512 nt
    s_waitcnt vmcnt(7)
    v_cndmask_b32 v78, v77, v76, s[88:89]
    v_add_f32 v83, v83, v76
    v_add_f32 v83, v83, v77
    v_lshlrev_b32 v79, 16, v124
    v_and_b32 v80, s84, v124
    v_fmac_f32 v20, v76, v79
    v_fmac_f32 v21, v76, v80
    v_lshlrev_b32 v79, 16, v125
    v_and_b32 v80, s84, v125
    v_fmac_f32 v22, v76, v79
    v_fmac_f32 v23, v76, v80
    v_lshlrev_b32 v79, 16, v126
    v_and_b32 v80, s84, v126
    v_fmac_f32 v24, v76, v79
    v_fmac_f32 v25, v76, v80
    v_lshlrev_b32 v79, 16, v127
    v_and_b32 v80, s84, v127
    v_fmac_f32 v26, v76, v79
    v_fmac_f32 v27, v76, v80
    v_lshlrev_b32 v79, 16, v128
    v_and_b32 v80, s84, v128
    v_fmac_f32 v28, v78, v79
    v_fmac_f32 v29, v78, v80
    v_lshlrev_b32 v79, 16, v129
    v_and_b32 v80, s84, v129
    v_fmac_f32 v30, v78, v79
    v_fmac_f32 v31, v78, v80
    v_lshlrev_b32 v79, 16, v130
    v_and_b32 v80, s84, v130
    v_fmac_f32 v32, v78, v79
    v_fmac_f32 v33, v78, v80
    v_lshlrev_b32 v79, 16, v131
    v_and_b32 v80, s84, v131
    v_fmac_f32 v34, v78, v79
    v_fmac_f32 v35, v78, v80
    v_lshlrev_b32 v79, 16, v132
    v_and_b32 v80, s84, v132
    v_fmac_f32 v36, v77, v79
    v_fmac_f32 v37, v77, v80
    v_lshlrev_b32 v79, 16, v133
    v_and_b32 v80, s84, v133
    v_fmac_f32 v38, v77, v79
    v_fmac_f32 v39, v77, v80
    v_lshlrev_b32 v79, 16, v134
    v_and_b32 v80, s84, v134
    v_fmac_f32 v40, v77, v79
    v_fmac_f32 v41, v77, v80
    v_lshlrev_b32 v79, 16, v135
    v_and_b32 v80, s84, v135
    v_fmac_f32 v42, v77, v79
    v_fmac_f32 v43, v77, v80
    s_branch L_pool_loop
L_pool_lastA:
    s_waitcnt vmcnt(0)
    v_cndmask_b32 v78, v77, v76, s[88:89]
    v_add_f32 v83, v83, v76
    v_add_f32 v83, v83, v77
    v_lshlrev_b32 v79, 16, v100
    v_and_b32 v80, s84, v100
    v_fmac_f32 v20, v76, v79
    v_fmac_f32 v21, v76, v80
    v_lshlrev_b32 v79, 16, v101
    v_and_b32 v80, s84, v101
    v_fmac_f32 v22, v76, v79
    v_fmac_f32 v23, v76, v80
    v_lshlrev_b32 v79, 16, v102
    v_and_b32 v80, s84, v102
    v_fmac_f32 v24, v76, v79
    v_fmac_f32 v25, v76, v80
    v_lshlrev_b32 v79, 16, v103
    v_and_b32 v80, s84, v103
    v_fmac_f32 v26, v76, v79
    v_fmac_f32 v27, v76, v80
    v_lshlrev_b32 v79, 16, v104
    v_and_b32 v80, s84, v104
    v_fmac_f32 v28, v78, v79
    v_fmac_f32 v29, v78, v80
    v_lshlrev_b32 v79, 16, v105
    v_and_b32 v80, s84, v105
    v_fmac_f32 v30, v78, v79
    v_fmac_f32 v31, v78, v80
    v_lshlrev_b32 v79, 16, v106
    v_and_b32 v80, s84, v106
    v_fmac_f32 v32, v78, v79
    v_fmac_f32 v33, v78, v80
    v_lshlrev_b32 v79, 16, v107
    v_and_b32 v80, s84, v107
    v_fmac_f32 v34, v78, v79
    v_fmac_f32 v35, v78, v80
    v_lshlrev_b32 v79, 16, v108
    v_and_b32 v80, s84, v108
    v_fmac_f32 v36, v77, v79
    v_fmac_f32 v37, v77, v80
    v_lshlrev_b32 v79, 16, v109
    v_and_b32 v80, s84, v109
    v_fmac_f32 v38, v77, v79
    v_fmac_f32 v39, v77, v80
    v_lshlrev_b32 v79, 16, v110
    v_and_b32 v80, s84, v110
    v_fmac_f32 v40, v77, v79
    v_fmac_f32 v41, v77, v80
    v_lshlrev_b32 v79, 16, v111
    v_and_b32 v80, s84, v111
    v_fmac_f32 v42, v77, v79
    v_fmac_f32 v43, v77, v80
    s_branch L_pool_done
L_pool_lastB:
    s_waitcnt vmcnt(0)
    v_cndmask_b32 v78, v77, v76, s[88:89]
    v_add_f32 v83, v83, v76
    v_add_f32 v83, v83, v77
    v_lshlrev_b32 v79, 16, v124
    v_and_b32 v80, s84, v124
    v_fmac_f32 v20, v76, v79
    v_fmac_f32 v21, v76, v80
    v_lshlrev_b32 v79, 16, v125
    v_and_b32 v80, s84, v125
    v_fmac_f32 v22, v76, v79
    v_fmac_f32 v23, v76, v80
    v_lshlrev_b32 v79, 16, v126
    v_and_b32 v80, s84, v126
    v_fmac_f32 v24, v76, v79
    v_fmac_f32 v25, v76, v80
    v_lshlrev_b32 v79, 16, v127
    v_and_b32 v80, s84, v127
    v_fmac_f32 v26, v76, v79
    v_fmac_f32 v27, v76, v80
    v_lshlrev_b32 v79, 16, v128
    v_and_b32 v80, s84, v128
    v_fmac_f32 v28, v78, v79
    v_fmac_f32 v29, v78, v80
    v_lshlrev_b32 v79, 16, v129
    v_and_b32 v80, s84, v129
    v_fmac_f32 v30, v78, v79
    v_fmac_f32 v31, v78, v80
    v_lshlrev_b32 v79, 16, v130
    v_and_b32 v80, s84, v130
    v_fmac_f32 v32, v78, v79
    v_fmac_f32 v33, v78, v80
    v_lshlrev_b32 v79, 16, v131
    v_and_b32 v80, s84, v131
    v_fmac_f32 v34, v78, v79
    v_fmac_f32 v35, v78, v80
    v_lshlrev_b32 v79, 16, v132
    v_and_b32 v80, s84, v132
    v_fmac_f32 v36, v77, v79
    v_fmac_f32 v37, v77, v80
    v_lshlrev_b32 v79, 16, v133
    v_and_b32 v80, s84, v133
    v_fmac_f32 v38, v77, v79
    v_fmac_f32 v39, v77, v80
    v_lshlrev_b32 v79, 16, v134
    v_and_b32 v80, s84, v134
    v_fmac_f32 v40, v77, v79
    v_fmac_f32 v41, v77, v80
    v_lshlrev_b32 v79, 16, v135
    v_and_b32 v80, s84, v135
    v_fmac_f32 v42, v77, v79
    v_fmac_f32 v43, v77, v80
L_pool_done:
    v_mov_b32 v76, v81
    v_mov_b32 v79, v81
    s_nop 1
    v_permlane32_swap_b32 v81, v79
    v_max_f32 v81, v81, v79
    v_mov_b32 v79, v81
    s_nop 1
    v_permlane16_swap_b32 v81, v79
    v_max_f32 v81, v81, v79
    v_sub_f32 v80, v76, v81
    v_mul_f32 v80, s85, v80
    v_exp_f32 v80, v80
    s_nop 0
    v_mul_f32 v83, v83, v80
    v_mul_f32 v20, v20, v80
    v_mul_f32 v21, v21, v80
    v_mul_f32 v22, v22, v80
    v_mul_f32 v23, v23, v80
    v_mul_f32 v24, v24, v80
    v_mul_f32 v25, v25, v80
    v_mul_f32 v26, v26, v80
    v_mul_f32 v27, v27, v80
    v_mul_f32 v28, v28, v80
    v_mul_f32 v29, v29, v80
    v_mul_f32 v30, v30, v80
    v_mul_f32 v31, v31, v80
    v_mul_f32 v32, v32, v80
    v_mul_f32 v33, v33, v80
    v_mul_f32 v34, v34, v80
    v_mul_f32 v35, v35, v80
    v_mul_f32 v36, v36, v80
    v_mul_f32 v37, v37, v80
    v_mul_f32 v38, v38, v80
    v_mul_f32 v39, v39, v80
    v_mul_f32 v40, v40, v80
    v_mul_f32 v41, v41, v80
    v_mul_f32 v42, v42, v80
    v_mul_f32 v43, v43, v80
    s_lshl_b32 s87, s81, 5
    s_add_u32 s87, s87, 4
    v_mov_b32 v17, s87
    buffer_load_dword v16, v17, s[72:75], 0 offen sc1
    s_nop 1
    v_permlane32_swap_b32 v20, v32
    v_permlane32_swap_b32 v21, v33
    v_permlane32_swap_b32 v22, v34
    v_permlane32_swap_b32 v23, v35
    v_permlane32_swap_b32 v24, v36
    v_permlane32_swap_b32 v25, v37
    v_permlane32_swap_b32 v26, v38
    v_permlane32_swap_b32 v27, v39
    v_permlane32_swap_b32 v28, v40
    v_permlane32_swap_b32 v29, v41
    v_permlane32_swap_b32 v30, v42
    v_permlane32_swap_b32 v31, v43
    v_add_f32 v20, v20, v32
    v_add_f32 v21, v21, v33
    v_add_f32 v22, v22, v34
    v_add_f32 v23, v23, v35
    v_add_f32 v24, v24, v36
    v_add_f32 v25, v25, v37
    v_add_f32 v26, v26, v38
    v_add_f32 v27, v27, v39
    v_add_f32 v28, v28, v40
    v_add_f32 v29, v29, v41
    v_add_f32 v30, v30, v42
    v_add_f32 v31, v31, v43
    s_nop 1
    v_permlane16_swap_b32 v20, v26
    v_permlane16_swap_b32 v21, v27
    v_permlane16_swap_b32 v22, v28
    v_permlane16_swap_b32 v23, v29
    v_permlane16_swap_b32 v24, v30
    v_permlane16_swap_b32 v25, v31
    v_add_f32 v20, v20, v26
    v_add_f32 v21, v21, v27
    v_add_f32 v22, v22, v28
    v_add_f32 v23, v23, v29
    v_add_f32 v24, v24, v30
    v_add_f32 v25, v25, v31
    v_and_b32 v7, 15, v3
    v_lshlrev_b32 v7, 5, v7
    s_mul_i32 s87, s82, 1536
    v_add_u32 v7, s87, v7
    v_lshrrev_b32 v4, 4, v3
    v_mul_u32_u24 v4, 6, v4
    v_add_u32 v5, 0, v4
    v_lshrrev_b32 v6, 3, v5
    v_lshl_add_u32 v6, v6, 9, v7
    v_and_b32 v5, 7, v5
    v_lshl_add_u32 v6, v5, 2, v6
    ds_write_b64 v6, v[20:21] offset:0
    v_add_u32 v5, 2, v4
    v_lshrrev_b32 v6, 3, v5
    v_lshl_add_u32 v6, v6, 9, v7
    v_and_b32 v5, 7, v5
    v_lshl_add_u32 v6, v5, 2, v6
    ds_write_b64 v6, v[22:23] offset:0
    v_add_u32 v5, 4, v4
    v_lshrrev_b32 v6, 3, v5
    v_lshl_add_u32 v6, v6, 9, v7
    v_and_b32 v5, 7, v5
    v_lshl_add_u32 v6, v5, 2, v6
    ds_write_b64 v6, v[24:25] offset:0
    v_mov_b32 v76, v83
    s_nop 1
    v_permlane32_swap_b32 v83, v76
    v_add_f32 v83, v83, v76
    v_mov_b32 v76, v83
    s_nop 1
    v_permlane16_swap_b32 v83, v76
    v_add_f32 v83, v83, v76
    s_lshl_b32 s87, s82, 3
    v_mov_b32 v4, s87
    v_mov_b32 v6, v81
    v_mov_b32 v7, v83
    ds_write_b64 v4, v[6:7] offset:12288
    s_waitcnt lgkmcnt(0)
    s_barrier
    s_lshl_b32 s92, s80, 3
    s_add_u32 s93, s92, s81
    s_cmp_lg_u32 s82, 0
    s_cbranch_scc1 L_t1done
    v_mov_b32 v4, 0
    ds_read_b128 v[88:91], v4 offset:12288
    ds_read_b128 v[92:95], v4 offset:12304
    ds_read_b128 v[96:99], v4 offset:12320
    ds_read_b128 v[100:103], v4 offset:12336
    v_lshlrev_b32 v5, 4, v3
    v_min_u32 v5, 752, v5
    ds_read_b128 v[20:23], v5 offset:0
    ds_read_b128 v[24:27], v5 offset:768
    ds_read_b128 v[28:31], v5 offset:1536
    ds_read_b128 v[32:35], v5 offset:2304
    ds_read_b128 v[36:39], v5 offset:3072
    ds_read_b128 v[40:43], v5 offset:3840
    ds_read_b128 v[44:47], v5 offset:4608
    ds_read_b128 v[48:51], v5 offset:5376
    ds_read_b128 v[52:55], v5 offset:6144
    ds_read_b128 v[56:59], v5 offset:6912
    ds_read_b128 v[60:63], v5 offset:7680
    ds_read_b128 v[64:67], v5 offset:8448
    ds_read_b128 v[68:71], v5 offset:9216
    ds_read_b128 v[72:75], v5 offset:9984
    ds_read_b128 v[76:79], v5 offset:10752
    ds_read_b128 v[80:83], v5 offset:11520
    s_waitcnt lgkmcnt(15)
    v_max3_f32 v6, v88, v90, v92
    v_max3_f32 v6, v6, v94, v96
    v_max3_f32 v6, v6, v98, v100
    v_max_f32 v6, v6, v102
    v_mul_f32 v7, s85, v6
    v_fma_f32 v88, v88, s85, -v7
    v_fma_f32 v90, v90, s85, -v7
    v_fma_f32 v92, v92, s85, -v7
    v_fma_f32 v94, v94, s85, -v7
    v_fma_f32 v96, v96, s85, -v7
    v_fma_f32 v98, v98, s85, -v7
    v_fma_f32 v100, v100, s85, -v7
    v_fma_f32 v102, v102, s85, -v7
    v_exp_f32 v88, v88
    v_exp_f32 v90, v90
    v_exp_f32 v92, v92
    v_exp_f32 v94, v94
    v_exp_f32 v96, v96
    v_exp_f32 v98, v98
    v_exp_f32 v100, v100
    v_exp_f32 v102, v102
    s_nop 0
    v_mul_f32 v7, v88, v89
    v_fmac_f32 v7, v90, v91
    v_fmac_f32 v7, v92, v93
    v_fmac_f32 v7, v94, v95
    v_fmac_f32 v7, v96, v97
    v_fmac_f32 v7, v98, v99
    v_fmac_f32 v7, v100, v101
    v_fmac_f32 v7, v102, v103
    s_waitcnt lgkmcnt(0)
    v_add_f32 v20, v20, v24
    v_add_f32 v21, v21, v25
    v_add_f32 v22, v22, v26
    v_add_f32 v23, v23, v27
    v_mul_f32 v8, v88, v20
    v_mul_f32 v9, v88, v21
    v_mul_f32 v10, v88, v22
    v_mul_f32 v11, v88, v23
    v_add_f32 v28, v28, v32
    v_add_f32 v29, v29, v33
    v_add_f32 v30, v30, v34
    v_add_f32 v31, v31, v35
    v_fmac_f32 v8, v90, v28
    v_fmac_f32 v9, v90, v29
    v_fmac_f32 v10, v90, v30
    v_fmac_f32 v11, v90, v31
    v_add_f32 v36, v36, v40
    v_add_f32 v37, v37, v41
    v_add_f32 v38, v38, v42
    v_add_f32 v39, v39, v43
    v_fmac_f32 v8, v92, v36
    v_fmac_f32 v9, v92, v37
    v_fmac_f32 v10, v92, v38
    v_fmac_f32 v11, v92, v39
    v_add_f32 v44, v44, v48
    v_add_f32 v45, v45, v49
    v_add_f32 v46, v46, v50
    v_add_f32 v47, v47, v51
    v_fmac_f32 v8, v94, v44
    v_fmac_f32 v9, v94, v45
    v_fmac_f32 v10, v94, v46
    v_fmac_f32 v11, v94, v47
    v_add_f32 v52, v52, v56
    v_add_f32 v53, v53, v57
    v_add_f32 v54, v54, v58
    v_add_f32 v55, v55, v59
    v_fmac_f32 v8, v96, v52
    v_fmac_f32 v9, v96, v53
    v_fmac_f32 v10, v96, v54
    v_fmac_f32 v11, v96, v55
    v_add_f32 v60, v60, v64
    v_add_f32 v61, v61, v65
    v_add_f32 v62, v62, v66
    v_add_f32 v63, v63, v67
    v_fmac_f32 v8, v98, v60
    v_fmac_f32 v9, v98, v61
    v_fmac_f32 v10, v98, v62
    v_fmac_f32 v11, v98, v63
    v_add_f32 v68, v68, v72
    v_add_f32 v69, v69, v73
    v_add_f32 v70, v70, v74
    v_add_f32 v71, v71, v75
    v_fmac_f32 v8, v100, v68
    v_fmac_f32 v9, v100, v69
    v_fmac_f32 v10, v100, v70
    v_fmac_f32 v11, v100, v71
    v_add_f32 v76, v76, v80
    v_add_f32 v77, v77, v81
    v_add_f32 v78, v78, v82
    v_add_f32 v79, v79, v83
    v_fmac_f32 v8, v102, v76
    v_fmac_f32 v9, v102, v77
    v_fmac_f32 v10, v102, v78
    v_fmac_f32 v11, v102, v79
    v_cmp_lt_u32 vcc, 47, v3
    s_nop 1
    v_cndmask_b32 v8, v8, v4, vcc
    v_cndmask_b32 v9, v9, v4, vcc
    v_cndmask_b32 v10, v10, v4, vcc
    v_cndmask_b32 v11, v11, v4, vcc
    v_cmp_eq_u32 vcc, 48, v3
    s_nop 1
    v_cndmask_b32 v8, v8, v6, vcc
    v_cndmask_b32 v9, v9, v7, vcc
    v_mov_b32 v12, 0x7fc00000
    v_cmp_eq_u32 vcc, -1, v8
    s_nop 1
    v_cndmask_b32 v8, v8, v12, vcc
    v_cmp_eq_u32 vcc, -1, v9
    s_nop 1
    v_cndmask_b32 v9, v9, v12, vcc
    v_cmp_eq_u32 vcc, -1, v10
    s_nop 1
    v_cndmask_b32 v10, v10, v12, vcc
    v_cmp_eq_u32 vcc, -1, v11
    s_nop 1
    v_cndmask_b32 v11, v11, v12, vcc
    s_lshl_b32 s87, s93, 10
    v_lshlrev_b32 v5, 4, v3
    v_add_u32 v5, s87, v5
    buffer_store_dwordx4 v[8:11], v5, s[76:79], 0 offen sc1
L_t1done:
    s_add_u32 s87, s92, s82
    s_lshl_b32 s87, s87, 10
    v_lshlrev_b32 v5, 4, v3
    v_add_u32 v6, s87, v5
    s_lshl_b32 s87, s82, 10
    v_add_u32 v13, s87, v5
    v_lshrrev_b32 v5, 4, v3
    s_lshl_b32 s87, s82, 2
    v_add_u32 v5, s87, v5
    v_and_b32 v14, 15, v3
    v_min_u32 v14, 5, v14
    v_lshl_add_u32 v14, v14, 5, v5
    v_lshlrev_b32 v14, 2, v14
    v_lshlrev_b32 v7, 2, v5
    ds_read_b32 v44, v7 offset:12352
    ds_read_b32 v45, v7 offset:12480
    v_mov_b32 v4, 0
    s_waitcnt lgkmcnt(0)
    v_lshrrev_b32 v74, 16, v44
    v_lshrrev_b32 v75, 16, v45
    v_dot2_f32_bf16 v60, v140, v74, 0
    v_dot2_f32_bf16 v61, v140, v44, 0
    v_dot2_f32_bf16 v62, v141, v74, 0
    v_dot2_f32_bf16 v63, v141, v44, 0
    v_dot2_f32_bf16 v64, v142, v74, 0
    v_dot2_f32_bf16 v65, v142, v44, 0
    v_dot2_f32_bf16 v66, v143, v74, 0
    v_dot2_f32_bf16 v67, v143, v44, 0
    v_dot2c_f32_bf16 v60, v136, v75
    v_dot2c_f32_bf16 v61, v136, v45
    v_dot2c_f32_bf16 v62, v137, v75
    v_dot2c_f32_bf16 v63, v137, v45
    v_dot2c_f32_bf16 v64, v138, v75
    v_dot2c_f32_bf16 v65, v138, v45
    v_dot2c_f32_bf16 v66, v139, v75
    v_dot2c_f32_bf16 v67, v139, v45
    s_mov_b32 s94, 400000
L_poll_3:
    buffer_load_dwordx4 v[8:11], v6, s[76:79], 0 offen offset:0 sc1
    s_waitcnt vmcnt(0)
    v_max_u32 v7, v8, v9
    v_max3_u32 v7, v7, v10, v11
    v_cmp_eq_u32 vcc, -1, v7
    s_nop 4
    s_cbranch_vccz L_pdone_4
    s_sub_u32 s94, s94, 1
    s_cmp_eq_u32 s94, 0
    s_cbranch_scc1 L_pdone_4
    s_sleep 1
    s_branch L_poll_3
L_pdone_4:
    ds_write_b128 v13, v[8:11] offset:13312
    s_waitcnt lgkmcnt(0)
    s_barrier
    ds_read_b64 v[20:21], v4 offset:14080
    ds_read_b64 v[22:23], v4 offset:15104
    ds_read_b64 v[24:25], v4 offset:16128
    ds_read_b64 v[26:27], v4 offset:17152
    ds_read_b64 v[28:29], v4 offset:18176
    ds_read_b64 v[30:31], v4 offset:19200
    ds_read_b64 v[32:33], v4 offset:20224
    ds_read_b64 v[34:35], v4 offset:21248
    ds_read_b32 v36, v14 offset:13312
    ds_read_b32 v37, v14 offset:14336
    ds_read_b32 v38, v14 offset:15360
    ds_read_b32 v39, v14 offset:16384
    ds_read_b32 v40, v14 offset:17408
    ds_read_b32 v41, v14 offset:18432
    ds_read_b32 v42, v14 offset:19456
    ds_read_b32 v43, v14 offset:20480
    s_waitcnt lgkmcnt(8)
    v_max3_f32 v6, v20, v22, v24
    v_max3_f32 v6, v6, v26, v28
    v_max3_f32 v6, v6, v30, v32
    v_max_f32 v6, v6, v34
    v_mul_f32 v7, s85, v6
    v_fma_f32 v20, v20, s85, -v7
    v_fma_f32 v22, v22, s85, -v7
    v_fma_f32 v24, v24, s85, -v7
    v_fma_f32 v26, v26, s85, -v7
    v_fma_f32 v28, v28, s85, -v7
    v_fma_f32 v30, v30, s85, -v7
    v_fma_f32 v32, v32, s85, -v7
    v_fma_f32 v34, v34, s85, -v7
    v_exp_f32 v20, v20
    v_exp_f32 v22, v22
    v_exp_f32 v24, v24
    v_exp_f32 v26, v26
    v_exp_f32 v28, v28
    v_exp_f32 v30, v30
    v_exp_f32 v32, v32
    v_exp_f32 v34, v34
    s_waitcnt lgkmcnt(0)
    v_mul_f32 v7, v20, v21
    v_mul_f32 v8, v20, v36
    v_fmac_f32 v7, v22, v23
    v_fmac_f32 v8, v22, v37
    v_fmac_f32 v7, v24, v25
    v_fmac_f32 v8, v24, v38
    v_fmac_f32 v7, v26, v27
    v_fmac_f32 v8, v26, v39
    v_fmac_f32 v7, v28, v29
    v_fmac_f32 v8, v28, v40
    v_fmac_f32 v7, v30, v31
    v_fmac_f32 v8, v30, v41
    v_fmac_f32 v7, v32, v33
    v_fmac_f32 v8, v32, v42
    v_fmac_f32 v7, v34, v35
    v_fmac_f32 v8, v34, v43
    v_rcp_f32 v7, v7
    s_nop 0
    v_mul_f32 v8, v8, v7
    v_cvt_pk_bf16_f32 v8, v8, v8
    v_lshlrev_b32 v8, 16, v8
    v_lshrrev_b32 v9, 16, v8
    s_nop 0
    v_mov_b32_dpp v46, v8 row_newbcast:0 row_mask:0xf bank_mask:0xf
    v_mov_b32_dpp v47, v8 row_newbcast:1 row_mask:0xf bank_mask:0xf
    v_mov_b32_dpp v48, v8 row_newbcast:2 row_mask:0xf bank_mask:0xf
    v_mov_b32_dpp v49, v8 row_newbcast:3 row_mask:0xf bank_mask:0xf
    v_mov_b32_dpp v50, v8 row_newbcast:4 row_mask:0xf bank_mask:0xf
    v_mov_b32_dpp v51, v8 row_newbcast:5 row_mask:0xf bank_mask:0xf
    v_mov_b32_dpp v68, v9 row_newbcast:0 row_mask:0xf bank_mask:0xf
    v_mov_b32_dpp v69, v9 row_newbcast:1 row_mask:0xf bank_mask:0xf
    v_mov_b32_dpp v70, v9 row_newbcast:2 row_mask:0xf bank_mask:0xf
    v_mov_b32_dpp v71, v9 row_newbcast:3 row_mask:0xf bank_mask:0xf
    v_mov_b32_dpp v72, v9 row_newbcast:4 row_mask:0xf bank_mask:0xf
    v_mov_b32_dpp v73, v9 row_newbcast:5 row_mask:0xf bank_mask:0xf
    v_dot2_f32_bf16 v52, v164, v68, 0
    v_dot2_f32_bf16 v53, v164, v46, 0
    v_dot2_f32_bf16 v54, v165, v68, 0
    v_dot2_f32_bf16 v55, v165, v46, 0
    v_dot2_f32_bf16 v56, v166, v68, 0
    v_dot2_f32_bf16 v57, v166, v46, 0
    v_dot2_f32_bf16 v58, v167, v68, 0
    v_dot2_f32_bf16 v59, v167, v46, 0
    v_dot2c_f32_bf16 v52, v160, v69
    v_dot2c_f32_bf16 v53, v160, v47
    v_dot2c_f32_bf16 v54, v161, v69
    v_dot2c_f32_bf16 v55, v161, v47
    v_dot2c_f32_bf16 v56, v162, v69
    v_dot2c_f32_bf16 v57, v162, v47
    v_dot2c_f32_bf16 v58, v163, v69
    v_dot2c_f32_bf16 v59, v163, v47
    v_dot2c_f32_bf16 v52, v156, v70
    v_dot2c_f32_bf16 v53, v156, v48
    v_dot2c_f32_bf16 v54, v157, v70
    v_dot2c_f32_bf16 v55, v157, v48
    v_dot2c_f32_bf16 v56, v158, v70
    v_dot2c_f32_bf16 v57, v158, v48
    v_dot2c_f32_bf16 v58, v159, v70
    v_dot2c_f32_bf16 v59, v159, v48
    v_dot2c_f32_bf16 v52, v152, v71
    v_dot2c_f32_bf16 v53, v152, v49
    v_dot2c_f32_bf16 v54, v153, v71
    v_dot2c_f32_bf16 v55, v153, v49
    v_dot2c_f32_bf16 v56, v154, v71
    v_dot2c_f32_bf16 v57, v154, v49
    v_dot2c_f32_bf16 v58, v155, v71
    v_dot2c_f32_bf16 v59, v155, v49
    v_dot2c_f32_bf16 v52, v148, v72
    v_dot2c_f32_bf16 v53, v148, v50
    v_dot2c_f32_bf16 v54, v149, v72
    v_dot2c_f32_bf16 v55, v149, v50
    v_dot2c_f32_bf16 v56, v150, v72
    v_dot2c_f32_bf16 v57, v150, v50
    v_dot2c_f32_bf16 v58, v151, v72
    v_dot2c_f32_bf16 v59, v151, v50
    v_dot2c_f32_bf16 v52, v144, v73
    v_dot2c_f32_bf16 v53, v144, v51
    v_dot2c_f32_bf16 v54, v145, v73
    v_dot2c_f32_bf16 v55, v145, v51
    v_dot2c_f32_bf16 v56, v146, v73
    v_dot2c_f32_bf16 v57, v146, v51
    v_dot2c_f32_bf16 v58, v147, v73
    v_dot2c_f32_bf16 v59, v147, v51
    s_nop 1
    s_nop 1
    v_permlane32_swap_b32 v52, v60
    v_permlane32_swap_b32 v53, v61
    v_permlane32_swap_b32 v54, v62
    v_permlane32_swap_b32 v55, v63
    v_permlane32_swap_b32 v56, v64
    v_permlane32_swap_b32 v57, v65
    v_permlane32_swap_b32 v58, v66
    v_permlane32_swap_b32 v59, v67
    v_add_f32 v52, v52, v60
    v_add_f32 v53, v53, v61
    v_add_f32 v54, v54, v62
    v_add_f32 v55, v55, v63
    v_add_f32 v56, v56, v64
    v_add_f32 v57, v57, v65
    v_add_f32 v58, v58, v66
    v_add_f32 v59, v59, v67
    s_nop 1
    v_permlane16_swap_b32 v52, v56
    v_permlane16_swap_b32 v53, v57
    v_permlane16_swap_b32 v54, v58
    v_permlane16_swap_b32 v55, v59
    v_add_f32 v52, v52, v56
    v_add_f32 v53, v53, v57
    v_add_f32 v54, v54, v58
    v_add_f32 v55, v55, v59
    v_lshrrev_b32 v5, 5, v3
    v_mul_u32_u24 v5, 512, v5
    v_bfe_u32 v6, v3, 4, 1
    v_lshl_add_u32 v5, v6, 4, v5
    v_and_b32 v6, 15, v3
    v_lshl_add_u32 v5, v6, 5, v5
    s_mul_i32 s87, s82, 1024
    v_add_u32 v5, s87, v5
    ds_write_b128 v5, v[52:55] offset:21504
    s_waitcnt lgkmcnt(0)
    s_barrier
    s_cmp_lg_u32 s82, 0
    s_cbranch_scc1 L_t4done
    v_lshlrev_b32 v5, 4, v3
    ds_read_b128 v[20:23], v5 offset:21504
    ds_read_b128 v[24:27], v5 offset:22528
    ds_read_b128 v[28:31], v5 offset:23552
    ds_read_b128 v[32:35], v5 offset:24576
    ds_read_b128 v[36:39], v5 offset:25600
    ds_read_b128 v[40:43], v5 offset:26624
    ds_read_b128 v[44:47], v5 offset:27648
    ds_read_b128 v[48:51], v5 offset:28672
    s_waitcnt lgkmcnt(0)
    v_add_f32 v20, v20, v24
    v_add_f32 v21, v21, v25
    v_add_f32 v22, v22, v26
    v_add_f32 v23, v23, v27
    v_add_f32 v28, v28, v32
    v_add_f32 v29, v29, v33
    v_add_f32 v30, v30, v34
    v_add_f32 v31, v31, v35
    v_add_f32 v36, v36, v40
    v_add_f32 v37, v37, v41
    v_add_f32 v38, v38, v42
    v_add_f32 v39, v39, v43
    v_add_f32 v44, v44, v48
    v_add_f32 v45, v45, v49
    v_add_f32 v46, v46, v50
    v_add_f32 v47, v47, v51
    v_add_f32 v20, v20, v28
    v_add_f32 v21, v21, v29
    v_add_f32 v22, v22, v30
    v_add_f32 v23, v23, v31
    v_add_f32 v36, v36, v44
    v_add_f32 v37, v37, v45
    v_add_f32 v38, v38, v46
    v_add_f32 v39, v39, v47
    v_add_f32 v20, v20, v36
    v_add_f32 v21, v21, v37
    v_add_f32 v22, v22, v38
    v_add_f32 v23, v23, v39
    v_mov_b32 v12, 0x7fc00000
    v_cmp_eq_u32 vcc, -1, v20
    s_nop 1
    v_cndmask_b32 v20, v20, v12, vcc
    v_cmp_eq_u32 vcc, -1, v21
    s_nop 1
    v_cndmask_b32 v21, v21, v12, vcc
    v_cmp_eq_u32 vcc, -1, v22
    s_nop 1
    v_cndmask_b32 v22, v22, v12, vcc
    v_cmp_eq_u32 vcc, -1, v23
    s_nop 1
    v_cndmask_b32 v23, v23, v12, vcc
    s_lshl_b32 s87, s81, 5
    s_add_u32 s87, s87, s80
    s_mul_i32 s87, s87, 1024
    s_add_u32 s87, s87, 262144
    v_add_u32 v5, s87, v5
    v_mov_b32 v6, 0x80000000
    v_cmp_gt_u32 vcc, 64, v3
    s_nop 1
    v_cndmask_b32 v5, v6, v5, vcc
    buffer_store_dwordx4 v[20:23], v5, s[76:79], 0 offen sc1
L_t4done:
    s_lshl_b32 s87, s81, 2
    s_cmp_lg_u32 s87, s80
    s_cbranch_scc1 L_end
    s_waitcnt vmcnt(0)
    s_mov_b32 s94, 400000
L_cspin_5:
    v_readlane_b32 s87, v16, 0
    s_nop 3
    s_and_b32 s87, s87, 0xffff
    s_cmp_ge_u32 s87, 32
    s_cbranch_scc1 L_cdone_6
    s_sub_u32 s94, s94, 1
    s_cmp_eq_u32 s94, 0
    s_cbranch_scc1 L_cdone_6
    s_sleep 32
    buffer_load_dword v16, v17, s[72:75], 0 offen sc1
    s_waitcnt vmcnt(0)
    s_branch L_cspin_5
L_cdone_6:
    s_lshl_b32 s87, s81, 5
    s_lshl_b32 s92, s82, 2
    s_add_u32 s87, s87, s92
    s_mul_i32 s87, s87, 1024
    s_add_u32 s87, s87, 262144
    v_lshlrev_b32 v5, 4, v3
    v_add_u32 v7, s87, v5
    v_mov_b32 v6, 0x80000000
    v_cmp_gt_u32 vcc, 64, v3
    s_nop 1
    v_cndmask_b32 v7, v6, v7, vcc
    s_mov_b32 s94, 400000
L_poll_7:
    buffer_load_dwordx4 v[20:23], v7, s[76:79], 0 offen offset:0 sc1
    buffer_load_dwordx4 v[24:27], v7, s[76:79], 0 offen offset:1024 sc1
    buffer_load_dwordx4 v[28:31], v7, s[76:79], 0 offen offset:2048 sc1
    buffer_load_dwordx4 v[32:35], v7, s[76:79], 0 offen offset:3072 sc1
    s_waitcnt vmcnt(0)
    v_max_u32 v8, v20, v21
    v_max3_u32 v8, v8, v22, v23
    v_max3_u32 v8, v8, v24, v25
    v_max3_u32 v8, v8, v26, v27
    v_max3_u32 v8, v8, v28, v29
    v_max3_u32 v8, v8, v30, v31
    v_max3_u32 v8, v8, v32, v33
    v_max3_u32 v8, v8, v34, v35
    v_cmp_eq_u32 vcc, -1, v8
    s_nop 4
    s_cbranch_vccz L_pdone_8
    s_sub_u32 s94, s94, 1
    s_cmp_eq_u32 s94, 0
    s_cbranch_scc1 L_pdone_8
    s_sleep 1
    s_branch L_poll_7
L_pdone_8:
    v_add_f32 v20, v20, v24
    v_add_f32 v28, v28, v32
    v_add_f32 v21, v21, v25
    v_add_f32 v29, v29, v33
    v_add_f32 v22, v22, v26
    v_add_f32 v30, v30, v34
    v_add_f32 v23, v23, v27
    v_add_f32 v31, v31, v35
    v_add_f32 v20, v20, v28
    v_add_f32 v21, v21, v29
    v_add_f32 v22, v22, v30
    v_add_f32 v23, v23, v31
    s_mul_i32 s87, s82, 1024
    v_add_u32 v5, s87, v5
    v_cmp_gt_u32 vcc, 64, v3
    s_and_saveexec_b64 s[96:97], vcc
    ds_write_b128 v5, v[20:23] offset:29696
    s_mov_b64 exec, s[96:97]
    s_waitcnt lgkmcnt(0)
    s_barrier
    s_cmp_gt_u32 s82, 1
    s_cbranch_scc1 L_end
    v_min_u32 v5, 127, v0
    v_lshlrev_b32 v5, 2, v5
    ds_read_b32 v20, v5 offset:29696
    ds_read_b32 v28, v5 offset:30208
    ds_read_b32 v21, v5 offset:30720
    ds_read_b32 v29, v5 offset:31232
    ds_read_b32 v22, v5 offset:31744
    ds_read_b32 v30, v5 offset:32256
    ds_read_b32 v23, v5 offset:32768
    ds_read_b32 v31, v5 offset:33280
    ds_read_b32 v24, v5 offset:33792
    ds_read_b32 v32, v5 offset:34304
    ds_read_b32 v25, v5 offset:34816
    ds_read_b32 v33, v5 offset:35328
    ds_read_b32 v26, v5 offset:35840
    ds_read_b32 v34, v5 offset:36352
    ds_read_b32 v27, v5 offset:36864
    ds_read_b32 v35, v5 offset:37376
    v_mov_b32 v4, 0
    ds_read_b32 v36, v4 offset:13308
    s_waitcnt lgkmcnt(0)
    v_add_f32 v20, v20, v21
    v_add_f32 v22, v22, v23
    v_add_f32 v24, v24, v25
    v_add_f32 v26, v26, v27
    v_add_f32 v20, v20, v22
    v_add_f32 v24, v24, v26
    v_add_f32 v20, v20, v24
    v_add_f32 v28, v28, v29
    v_add_f32 v30, v30, v31
    v_add_f32 v32, v32, v33
    v_add_f32 v34, v34, v35
    v_add_f32 v28, v28, v30
    v_add_f32 v32, v32, v34
    v_add_f32 v28, v28, v32
    v_cvt_pk_bf16_f32 v20, v20, v20
    v_lshlrev_b32 v20, 16, v20
    v_cvt_pk_bf16_f32 v28, v28, v28
    v_lshlrev_b32 v28, 16, v28
    v_mul_f32 v20, v36, v20
    v_cvt_pk_bf16_f32 v20, v20, v20
    v_lshlrev_b32 v20, 16, v20
    v_sub_f32 v21, 1.0, v36
    v_cvt_pk_bf16_f32 v21, v21, v21
    v_lshlrev_b32 v21, 16, v21
    v_mul_f32 v21, v21, v28
    v_cvt_pk_bf16_f32 v21, v21, v21
    v_lshlrev_b32 v21, 16, v21
    v_add_f32 v20, v20, v21
    v_cvt_pk_bf16_f32 v20, v20, v20
    s_lshl_b32 s87, s101, 3
    v_lshlrev_b32 v5, 1, v0
    v_add_u32 v5, s100, v5
    v_mov_b32 v6, 0x80000000
    v_cmp_gt_u32 vcc, s87, v0
    s_nop 1
    v_cndmask_b32 v5, v6, v5, vcc
    buffer_store_short v20, v5, s[68:71], 0 offen
    s_branch L_end
L_helper:
    s_sub_u32 s31, s82, 8
    v_mov_b32 v63, 0x80000000
    v_lshlrev_b32 v8, 4, v3
    v_mov_b32 v57, v63
    v_mov_b32 v20, 0
    v_mov_b32 v21, 0
    v_mov_b32 v22, 0
    v_mov_b32 v23, 0
    v_mov_b32 v24, 0
    v_mov_b32 v25, 0
    v_mov_b32 v26, 0
    v_mov_b32 v27, 0
    v_mov_b32 v28, 0
    v_mov_b32 v29, 0
    v_mov_b32 v30, 0
    v_mov_b32 v31, 0
    v_mov_b32 v32, 0
    v_mov_b32 v33, 0
    v_mov_b32 v34, 0
    v_mov_b32 v35, 0
    v_mov_b32 v36, 0
    v_mov_b32 v37, 0
    v_mov_b32 v38, 0
    v_mov_b32 v39, 0
    v_mov_b32 v40, 0
    v_mov_b32 v41, 0
    v_mov_b32 v42, 0
    v_mov_b32 v43, 0
    s_cmp_lg_u32 s31, 0
    s_cbranch_scc1 L_noclear
    v_mov_b32 v4, -1
    v_mov_b32 v5, -1
    v_mov_b32 v6, -1
    v_mov_b32 v7, -1
    s_mul_i32 s92, s95, 1408
    s_add_u32 s92, s92, 524288
    v_add_u32 v11, s92, v8
    buffer_store_dwordx4 v[4:7], v11, s[76:79], 0 offen sc1
    v_cmp_gt_u32 vcc, 17, v3
    s_nop 1
    v_cndmask_b32 v11, v63, v11, vcc
    buffer_store_dwordx4 v[4:7], v11, s[76:79], 0 offen offset:1024 sc1
    s_lshl_b32 s92, s95, 10
    v_add_u32 v9, s92, v8
    buffer_store_dwordx4 v[4:7], v9, s[76:79], 0 offen sc1
    s_lshl_b32 s92, s81, 5
    s_add_u32 s92, s92, s80
    s_mul_i32 s92, s92, 1024
    s_add_u32 s92, s92, 262144
    v_add_u32 v10, s92, v8
    v_cmp_gt_u32 vcc, 64, v3
    s_nop 1
    v_cndmask_b32 v10, v63, v10, vcc
    buffer_store_dwordx4 v[4:7], v10, s[76:79], 0 offen sc1
    s_lshl_b32 s92, s80, 7
    s_add_u32 s92, s92, 884736
    s_cmp_eq_u32 s81, 0
    s_cselect_b32 s92, s92, 0x80000000
    v_mov_b32 v12, s92
    v_cmp_eq_u32 vcc, 0, v3
    s_nop 1
    v_cndmask_b32 v12, v63, v12, vcc
    buffer_store_dword v20, v12, s[76:79], 0 offen sc1
    v_mov_b32 v12, 13248
    ds_write_b128 v12, v[20:23]
    v_mov_b32 v12, 13300
    ds_write_b32 v12, v20
    ds_write_b32 v12, v20 offset:4
L_noclear:
    s_mul_i32 s87, s81, 80
    s_mul_i32 s92, s31, 10
    s_add_u32 s92, s87, s92
    v_mul_u32_u24 v60, 20, v59
    v_add_u32 v60, s92, v60
    v_lshlrev_b32 v61, 1, v60
    s_mov_b32 s92, 12288
    v_mul_lo_u32 v60, v60, s92
    v_lshl_add_u32 v54, v58, 4, v60
    v_add_u32 v56, 12416, v54
    v_add_u32 v62, 256, v54
    v_add_u32 v60, 12160, v54
    v_cndmask_b32 v55, v60, v62, s[88:89]
    buffer_load_dwordx4 v[44:47], v61, s[60:63], 0 offen
    buffer_load_dword v48, v61, s[60:63], 0 offen offset:16
    s_mov_b32 s83, 0
    buffer_load_dwordx4 v[64:67], v54, s[40:43], s83 offen nt
    buffer_load_dwordx4 v[68:71], v55, s[40:43], s83 offen nt
    buffer_load_dwordx4 v[72:75], v56, s[40:43], s83 offen nt
    s_mov_b32 s83, 24576
    buffer_load_dwordx4 v[76:79], v54, s[40:43], s83 offen nt
    buffer_load_dwordx4 v[80:83], v55, s[40:43], s83 offen nt
    buffer_load_dwordx4 v[84:87], v56, s[40:43], s83 offen nt
    s_mov_b32 s83, 49152
    buffer_load_dwordx4 v[88:91], v54, s[40:43], s83 offen nt
    buffer_load_dwordx4 v[92:95], v55, s[40:43], s83 offen nt
    buffer_load_dwordx4 v[96:99], v56, s[40:43], s83 offen nt
    s_mov_b32 s83, 73728
    buffer_load_dwordx4 v[100:103], v54, s[40:43], s83 offen nt
    buffer_load_dwordx4 v[104:107], v55, s[40:43], s83 offen nt
    buffer_load_dwordx4 v[108:111], v56, s[40:43], s83 offen nt
    s_mov_b32 s83, 98304
    buffer_load_dwordx4 v[112:115], v54, s[40:43], s83 offen nt
    buffer_load_dwordx4 v[116:119], v55, s[40:43], s83 offen nt
    buffer_load_dwordx4 v[120:123], v56, s[40:43], s83 offen nt
    s_cmp_lg_u32 s31, 0
    s_cbranch_scc1 L_h1pre
    s_lshl_b32 s92, s80, 3
    v_mov_b32 v10, s92
    v_cmp_eq_u32 vcc, 0, v3
    v_mov_b32 v13, 1
    s_nop 0
    v_cndmask_b32 v10, v63, v10, vcc
    s_waitcnt lgkmcnt(0)
    s_barrier
    s_waitcnt vmcnt(17)
    buffer_atomic_add v13, v10, s[72:75], 0 offen sc0
    v_mov_b32 v12, 13300
    v_mov_b32 v14, 1
    ds_write_b32 v12, v14
    s_branch L_hq
L_h1pre:
    v_lshrrev_b32 v9, 3, v3
    v_mul_u32_u24 v9, 10, v9
    v_add_u32 v9, s87, v9
    v_lshlrev_b32 v10, 1, v9
    v_mul_u32_u24 v9, 3072, v9
    v_and_b32 v11, 7, v3
    v_lshl_add_u32 v9, v11, 4, v9
    s_cmp_eq_u32 s15, 1
    s_cselect_b64 vcc, -1, 0
    s_nop 1
    v_cndmask_b32 v57, v63, v9, vcc
    buffer_load_dwordx4 v[12:15], v10, s[60:63], 0 offen
    buffer_load_dword v16, v10, s[60:63], 0 offen offset:16
    s_mov_b32 s83, 0
    buffer_load_dwordx4 v[124:127], v57, s[48:51], s83 offen nt
    buffer_load_dwordx4 v[128:131], v57, s[52:55], s83 offen nt
    s_mov_b32 s83, 3072
    buffer_load_dwordx4 v[132:135], v57, s[48:51], s83 offen nt
    buffer_load_dwordx4 v[136:139], v57, s[52:55], s83 offen nt
    s_mov_b32 s83, 6144
    buffer_load_dwordx4 v[140:143], v57, s[48:51], s83 offen nt
    buffer_load_dwordx4 v[144:147], v57, s[52:55], s83 offen nt
    s_mov_b32 s83, 9216
    buffer_load_dwordx4 v[148:151], v57, s[48:51], s83 offen nt
    buffer_load_dwordx4 v[152:155], v57, s[52:55], s83 offen nt
    s_mov_b32 s83, 12288
    buffer_load_dwordx4 v[156:159], v57, s[48:51], s83 offen nt
    buffer_load_dwordx4 v[160:163], v57, s[52:55], s83 offen nt
    s_barrier
L_hq:
    s_cmp_eq_u32 s31, 1
    s_cbranch_scc1 L_hw_9a
    s_waitcnt vmcnt(13)
    s_branch L_hw_9b
L_hw_9a:
    s_waitcnt vmcnt(24)
L_hw_9b:
    v_lshlrev_b32 v4, 16, v44
    v_and_b32 v5, s84, v44
    v_cndmask_b32 v6, v5, v4, s[88:89]
    v_lshlrev_b32 v7, 16, v64
    v_and_b32 v9, s84, v64
    v_fmac_f32 v20, v4, v7
    v_fmac_f32 v21, v4, v9
    v_lshlrev_b32 v7, 16, v65
    v_and_b32 v9, s84, v65
    v_fmac_f32 v22, v4, v7
    v_fmac_f32 v23, v4, v9
    v_lshlrev_b32 v7, 16, v66
    v_and_b32 v9, s84, v66
    v_fmac_f32 v24, v4, v7
    v_fmac_f32 v25, v4, v9
    v_lshlrev_b32 v7, 16, v67
    v_and_b32 v9, s84, v67
    v_fmac_f32 v26, v4, v7
    v_fmac_f32 v27, v4, v9
    v_lshlrev_b32 v7, 16, v68
    v_and_b32 v9, s84, v68
    v_fmac_f32 v28, v6, v7
    v_fmac_f32 v29, v6, v9
    v_lshlrev_b32 v7, 16, v69
    v_and_b32 v9, s84, v69
    v_fmac_f32 v30, v6, v7
    v_fmac_f32 v31, v6, v9
    v_lshlrev_b32 v7, 16, v70
    v_and_b32 v9, s84, v70
    v_fmac_f32 v32, v6, v7
    v_fmac_f32 v33, v6, v9
    v_lshlrev_b32 v7, 16, v71
    v_and_b32 v9, s84, v71
    v_fmac_f32 v34, v6, v7
    v_fmac_f32 v35, v6, v9
    v_lshlrev_b32 v7, 16, v72
    v_and_b32 v9, s84, v72
    v_fmac_f32 v36, v5, v7
    v_fmac_f32 v37, v5, v9
    v_lshlrev_b32 v7, 16, v73
    v_and_b32 v9, s84, v73
    v_fmac_f32 v38, v5, v7
    v_fmac_f32 v39, v5, v9
    v_lshlrev_b32 v7, 16, v74
    v_and_b32 v9, s84, v74
    v_fmac_f32 v40, v5, v7
    v_fmac_f32 v41, v5, v9
    v_lshlrev_b32 v7, 16, v75
    v_and_b32 v9, s84, v75
    v_fmac_f32 v42, v5, v7
    v_fmac_f32 v43, v5, v9
    s_cmp_eq_u32 s31, 1
    s_cbranch_scc1 L_hw_10a
    s_waitcnt vmcnt(10)
    s_branch L_hw_10b
L_hw_10a:
    s_waitcnt vmcnt(21)
L_hw_10b:
    v_lshlrev_b32 v4, 16, v45
    v_and_b32 v5, s84, v45
    v_cndmask_b32 v6, v5, v4, s[88:89]
    v_lshlrev_b32 v7, 16, v76
    v_and_b32 v9, s84, v76
    v_fmac_f32 v20, v4, v7
    v_fmac_f32 v21, v4, v9
    v_lshlrev_b32 v7, 16, v77
    v_and_b32 v9, s84, v77
    v_fmac_f32 v22, v4, v7
    v_fmac_f32 v23, v4, v9
    v_lshlrev_b32 v7, 16, v78
    v_and_b32 v9, s84, v78
    v_fmac_f32 v24, v4, v7
    v_fmac_f32 v25, v4, v9
    v_lshlrev_b32 v7, 16, v79
    v_and_b32 v9, s84, v79
    v_fmac_f32 v26, v4, v7
    v_fmac_f32 v27, v4, v9
    v_lshlrev_b32 v7, 16, v80
    v_and_b32 v9, s84, v80
    v_fmac_f32 v28, v6, v7
    v_fmac_f32 v29, v6, v9
    v_lshlrev_b32 v7, 16, v81
    v_and_b32 v9, s84, v81
    v_fmac_f32 v30, v6, v7
    v_fmac_f32 v31, v6, v9
    v_lshlrev_b32 v7, 16, v82
    v_and_b32 v9, s84, v82
    v_fmac_f32 v32, v6, v7
    v_fmac_f32 v33, v6, v9
    v_lshlrev_b32 v7, 16, v83
    v_and_b32 v9, s84, v83
    v_fmac_f32 v34, v6, v7
    v_fmac_f32 v35, v6, v9
    v_lshlrev_b32 v7, 16, v84
    v_and_b32 v9, s84, v84
    v_fmac_f32 v36, v5, v7
    v_fmac_f32 v37, v5, v9
    v_lshlrev_b32 v7, 16, v85
    v_and_b32 v9, s84, v85
    v_fmac_f32 v38, v5, v7
    v_fmac_f32 v39, v5, v9
    v_lshlrev_b32 v7, 16, v86
    v_and_b32 v9, s84, v86
    v_fmac_f32 v40, v5, v7
    v_fmac_f32 v41, v5, v9
    v_lshlrev_b32 v7, 16, v87
    v_and_b32 v9, s84, v87
    v_fmac_f32 v42, v5, v7
    v_fmac_f32 v43, v5, v9
    s_cmp_eq_u32 s31, 1
    s_cbranch_scc1 L_hw_11a
    s_waitcnt vmcnt(7)
    s_branch L_hw_11b
L_hw_11a:
    s_waitcnt vmcnt(18)
L_hw_11b:
    v_lshlrev_b32 v4, 16, v46
    v_and_b32 v5, s84, v46
    v_cndmask_b32 v6, v5, v4, s[88:89]
    v_lshlrev_b32 v7, 16, v88
    v_and_b32 v9, s84, v88
    v_fmac_f32 v20, v4, v7
    v_fmac_f32 v21, v4, v9
    v_lshlrev_b32 v7, 16, v89
    v_and_b32 v9, s84, v89
    v_fmac_f32 v22, v4, v7
    v_fmac_f32 v23, v4, v9
    v_lshlrev_b32 v7, 16, v90
    v_and_b32 v9, s84, v90
    v_fmac_f32 v24, v4, v7
    v_fmac_f32 v25, v4, v9
    v_lshlrev_b32 v7, 16, v91
    v_and_b32 v9, s84, v91
    v_fmac_f32 v26, v4, v7
    v_fmac_f32 v27, v4, v9
    v_lshlrev_b32 v7, 16, v92
    v_and_b32 v9, s84, v92
    v_fmac_f32 v28, v6, v7
    v_fmac_f32 v29, v6, v9
    v_lshlrev_b32 v7, 16, v93
    v_and_b32 v9, s84, v93
    v_fmac_f32 v30, v6, v7
    v_fmac_f32 v31, v6, v9
    v_lshlrev_b32 v7, 16, v94
    v_and_b32 v9, s84, v94
    v_fmac_f32 v32, v6, v7
    v_fmac_f32 v33, v6, v9
    v_lshlrev_b32 v7, 16, v95
    v_and_b32 v9, s84, v95
    v_fmac_f32 v34, v6, v7
    v_fmac_f32 v35, v6, v9
    v_lshlrev_b32 v7, 16, v96
    v_and_b32 v9, s84, v96
    v_fmac_f32 v36, v5, v7
    v_fmac_f32 v37, v5, v9
    v_lshlrev_b32 v7, 16, v97
    v_and_b32 v9, s84, v97
    v_fmac_f32 v38, v5, v7
    v_fmac_f32 v39, v5, v9
    v_lshlrev_b32 v7, 16, v98
    v_and_b32 v9, s84, v98
    v_fmac_f32 v40, v5, v7
    v_fmac_f32 v41, v5, v9
    v_lshlrev_b32 v7, 16, v99
    v_and_b32 v9, s84, v99
    v_fmac_f32 v42, v5, v7
    v_fmac_f32 v43, v5, v9
    s_cmp_eq_u32 s31, 1
    s_cbranch_scc1 L_hw_12a
    s_waitcnt vmcnt(4)
    s_branch L_hw_12b
L_hw_12a:
    s_waitcnt vmcnt(15)
L_hw_12b:
    v_lshlrev_b32 v4, 16, v47
    v_and_b32 v5, s84, v47
    v_cndmask_b32 v6, v5, v4, s[88:89]
    v_lshlrev_b32 v7, 16, v100
    v_and_b32 v9, s84, v100
    v_fmac_f32 v20, v4, v7
    v_fmac_f32 v21, v4, v9
    v_lshlrev_b32 v7, 16, v101
    v_and_b32 v9, s84, v101
    v_fmac_f32 v22, v4, v7
    v_fmac_f32 v23, v4, v9
    v_lshlrev_b32 v7, 16, v102
    v_and_b32 v9, s84, v102
    v_fmac_f32 v24, v4, v7
    v_fmac_f32 v25, v4, v9
    v_lshlrev_b32 v7, 16, v103
    v_and_b32 v9, s84, v103
    v_fmac_f32 v26, v4, v7
    v_fmac_f32 v27, v4, v9
    v_lshlrev_b32 v7, 16, v104
    v_and_b32 v9, s84, v104
    v_fmac_f32 v28, v6, v7
    v_fmac_f32 v29, v6, v9
    v_lshlrev_b32 v7, 16, v105
    v_and_b32 v9, s84, v105
    v_fmac_f32 v30, v6, v7
    v_fmac_f32 v31, v6, v9
    v_lshlrev_b32 v7, 16, v106
    v_and_b32 v9, s84, v106
    v_fmac_f32 v32, v6, v7
    v_fmac_f32 v33, v6, v9
    v_lshlrev_b32 v7, 16, v107
    v_and_b32 v9, s84, v107
    v_fmac_f32 v34, v6, v7
    v_fmac_f32 v35, v6, v9
    v_lshlrev_b32 v7, 16, v108
    v_and_b32 v9, s84, v108
    v_fmac_f32 v36, v5, v7
    v_fmac_f32 v37, v5, v9
    v_lshlrev_b32 v7, 16, v109
    v_and_b32 v9, s84, v109
    v_fmac_f32 v38, v5, v7
    v_fmac_f32 v39, v5, v9
    v_lshlrev_b32 v7, 16, v110
    v_and_b32 v9, s84, v110
    v_fmac_f32 v40, v5, v7
    v_fmac_f32 v41, v5, v9
    v_lshlrev_b32 v7, 16, v111
    v_and_b32 v9, s84, v111
    v_fmac_f32 v42, v5, v7
    v_fmac_f32 v43, v5, v9
    s_cmp_eq_u32 s31, 1
    s_cbranch_scc1 L_hw_13a
    s_waitcnt vmcnt(1)
    s_branch L_hw_13b
L_hw_13a:
    s_waitcnt vmcnt(12)
L_hw_13b:
    v_lshlrev_b32 v4, 16, v48
    v_and_b32 v5, s84, v48
    v_cndmask_b32 v6, v5, v4, s[88:89]
    v_lshlrev_b32 v7, 16, v112
    v_and_b32 v9, s84, v112
    v_fmac_f32 v20, v4, v7
    v_fmac_f32 v21, v4, v9
    v_lshlrev_b32 v7, 16, v113
    v_and_b32 v9, s84, v113
    v_fmac_f32 v22, v4, v7
    v_fmac_f32 v23, v4, v9
    v_lshlrev_b32 v7, 16, v114
    v_and_b32 v9, s84, v114
    v_fmac_f32 v24, v4, v7
    v_fmac_f32 v25, v4, v9
    v_lshlrev_b32 v7, 16, v115
    v_and_b32 v9, s84, v115
    v_fmac_f32 v26, v4, v7
    v_fmac_f32 v27, v4, v9
    v_lshlrev_b32 v7, 16, v116
    v_and_b32 v9, s84, v116
    v_fmac_f32 v28, v6, v7
    v_fmac_f32 v29, v6, v9
    v_lshlrev_b32 v7, 16, v117
    v_and_b32 v9, s84, v117
    v_fmac_f32 v30, v6, v7
    v_fmac_f32 v31, v6, v9
    v_lshlrev_b32 v7, 16, v118
    v_and_b32 v9, s84, v118
    v_fmac_f32 v32, v6, v7
    v_fmac_f32 v33, v6, v9
    v_lshlrev_b32 v7, 16, v119
    v_and_b32 v9, s84, v119
    v_fmac_f32 v34, v6, v7
    v_fmac_f32 v35, v6, v9
    v_lshlrev_b32 v7, 16, v120
    v_and_b32 v9, s84, v120
    v_fmac_f32 v36, v5, v7
    v_fmac_f32 v37, v5, v9
    v_lshlrev_b32 v7, 16, v121
    v_and_b32 v9, s84, v121
    v_fmac_f32 v38, v5, v7
    v_fmac_f32 v39, v5, v9
    v_lshlrev_b32 v7, 16, v122
    v_and_b32 v9, s84, v122
    v_fmac_f32 v40, v5, v7
    v_fmac_f32 v41, v5, v9
    v_lshlrev_b32 v7, 16, v123
    v_and_b32 v9, s84, v123
    v_fmac_f32 v42, v5, v7
    v_fmac_f32 v43, v5, v9
    s_nop 1
    v_permlane32_swap_b32 v20, v32
    v_permlane32_swap_b32 v21, v33
    v_permlane32_swap_b32 v22, v34
    v_permlane32_swap_b32 v23, v35
    v_permlane32_swap_b32 v24, v36
    v_permlane32_swap_b32 v25, v37
    v_permlane32_swap_b32 v26, v38
    v_permlane32_swap_b32 v27, v39
    v_permlane32_swap_b32 v28, v40
    v_permlane32_swap_b32 v29, v41
    v_permlane32_swap_b32 v30, v42
    v_permlane32_swap_b32 v31, v43
    v_add_f32 v20, v20, v32
    v_add_f32 v21, v21, v33
    v_add_f32 v22, v22, v34
    v_add_f32 v23, v23, v35
    v_add_f32 v24, v24, v36
    v_add_f32 v25, v25, v37
    v_add_f32 v26, v26, v38
    v_add_f32 v27, v27, v39
    v_add_f32 v28, v28, v40
    v_add_f32 v29, v29, v41
    v_add_f32 v30, v30, v42
    v_add_f32 v31, v31, v43
    s_nop 1
    v_permlane16_swap_b32 v20, v26
    v_permlane16_swap_b32 v21, v27
    v_permlane16_swap_b32 v22, v28
    v_permlane16_swap_b32 v23, v29
    v_permlane16_swap_b32 v24, v30
    v_permlane16_swap_b32 v25, v31
    v_add_f32 v20, v20, v26
    v_add_f32 v21, v21, v27
    v_add_f32 v22, v22, v28
    v_add_f32 v23, v23, v29
    v_add_f32 v24, v24, v30
    v_add_f32 v25, v25, v31
    v_and_b32 v7, 15, v3
    v_lshlrev_b32 v7, 5, v7
    s_mul_i32 s87, s31, 1536
    v_add_u32 v7, s87, v7
    v_lshrrev_b32 v4, 4, v3
    v_mul_u32_u24 v4, 6, v4
    v_add_u32 v5, 0, v4
    v_lshrrev_b32 v6, 3, v5
    v_lshl_add_u32 v6, v6, 9, v7
    v_and_b32 v5, 7, v5
    v_lshl_add_u32 v6, v5, 2, v6
    ds_write_b64 v6, v[20:21] offset:0
    v_add_u32 v5, 2, v4
    v_lshrrev_b32 v6, 3, v5
    v_lshl_add_u32 v6, v6, 9, v7
    v_and_b32 v5, 7, v5
    v_lshl_add_u32 v6, v5, 2, v6
    ds_write_b64 v6, v[22:23] offset:0
    v_add_u32 v5, 4, v4
    v_lshrrev_b32 v6, 3, v5
    v_lshl_add_u32 v6, v6, 9, v7
    v_and_b32 v5, 7, v5
    v_lshl_add_u32 v6, v5, 2, v6
    ds_write_b64 v6, v[24:25] offset:0
    s_waitcnt lgkmcnt(0)
    s_cmp_eq_u32 s31, 1
    s_cbranch_scc1 L_h1
    v_mov_b32 v12, 13304
    s_mov_b32 s94, 3200000
L_h0flag:
    ds_read_b32 v14, v12
    s_waitcnt lgkmcnt(0)
    v_readfirstlane_b32 s30, v14
    s_sub_u32 s94, s94, 1
    s_cmp_eq_u32 s94, 0
    s_cbranch_scc1 L_h0go
    s_cmp_eq_u32 s30, 0
    s_cbranch_scc1 L_h0flag
L_h0go:
    v_min_u32 v5, 752, v8
    ds_read_b128 v[20:23], v5 offset:0
    ds_read_b128 v[24:27], v5 offset:768
    ds_read_b128 v[28:31], v5 offset:1536
    ds_read_b128 v[32:35], v5 offset:2304
    s_mul_i32 s87, s95, 1408
    s_add_u32 s87, s87, 524288
    v_add_u32 v9, s87, v8
    v_cmp_gt_u32 s[90:91], 48, v3
    s_nop 1
    v_cndmask_b32 v9, v63, v9, s[90:91]
    s_waitcnt lgkmcnt(0)
    v_add_f32 v20, v20, v24
    v_add_f32 v28, v28, v32
    v_add_f32 v21, v21, v25
    v_add_f32 v29, v29, v33
    v_add_f32 v22, v22, v26
    v_add_f32 v30, v30, v34
    v_add_f32 v23, v23, v27
    v_add_f32 v31, v31, v35
    v_add_f32 v20, v20, v28
    v_add_f32 v21, v21, v29
    v_add_f32 v22, v22, v30
    v_add_f32 v23, v23, v31
    v_mov_b32 v12, 0x7fc00000
    v_cmp_eq_u32 vcc, -1, v20
    s_nop 1
    v_cndmask_b32 v20, v20, v12, vcc
    v_cmp_eq_u32 vcc, -1, v21
    s_nop 1
    v_cndmask_b32 v21, v21, v12, vcc
    v_cmp_eq_u32 vcc, -1, v22
    s_nop 1
    v_cndmask_b32 v22, v22, v12, vcc
    v_cmp_eq_u32 vcc, -1, v23
    s_nop 1
    v_cndmask_b32 v23, v23, v12, vcc
    buffer_store_dwordx4 v[20:23], v9, s[76:79], 0 offen sc1
    s_waitcnt vmcnt(1)
    v_readfirstlane_b32 s30, v13
    s_mul_i32 s87, s80, 11264
    s_add_u32 s87, s87, 525568
    s_and_b32 s30, s30, 7
    s_cmp_lg_u32 s30, 7
    s_cbranch_scc1 L_h0nogo
    v_mul_u32_u24 v9, 1408, v3
    v_add_u32 v9, s87, v9
    v_cmp_gt_u32 vcc, 8, v3
    v_mov_b32 v12, 0
    s_nop 0
    v_cndmask_b32 v9, v63, v9, vcc
    buffer_store_dword v12, v9, s[76:79], 0 offen sc1
L_h0nogo:
    s_mul_i32 s87, s95, 1408
    s_add_u32 s87, s87, 525568
    v_mov_b32 v10, s87
    buffer_load_dword v13, v10, s[76:79], 0 offen sc1
    s_waitcnt vmcnt(0)
    s_mov_b32 s94, 400000
L_h0gospin:
    v_readfirstlane_b32 s30, v13
    s_sub_u32 s94, s94, 1
    s_cmp_eq_u32 s94, 0
    s_cbranch_scc1 L_h0godone
    s_cmp_lg_u32 s30, -1
    s_cbranch_scc1 L_h0godone
    s_sleep 1
    buffer_load_dword v13, v10, s[76:79], 0 offen sc1
    s_waitcnt vmcnt(0)
    s_branch L_h0gospin
L_h0godone:
    s_mul_i32 s87, s80, 11264
    s_add_u32 s87, s87, 524288
    v_add_u32 v9, s87, v8
    v_cndmask_b32 v9, v63, v9, s[90:91]
    s_mov_b32 s94, 400000
L_poll_14:
    s_mov_b32 s83, 0
    buffer_load_dwordx4 v[64:67], v9, s[76:79], s83 offen sc1
    s_mov_b32 s83, 1408
    buffer_load_dwordx4 v[68:71], v9, s[76:79], s83 offen sc1
    s_mov_b32 s83, 2816
    buffer_load_dwordx4 v[72:75], v9, s[76:79], s83 offen sc1
    s_mov_b32 s83, 4224
    buffer_load_dwordx4 v[76:79], v9, s[76:79], s83 offen sc1
    s_mov_b32 s83, 5632
    buffer_load_dwordx4 v[80:83], v9, s[76:79], s83 offen sc1
    s_mov_b32 s83, 7040
    buffer_load_dwordx4 v[84:87], v9, s[76:79], s83 offen sc1
    s_mov_b32 s83, 8448
    buffer_load_dwordx4 v[88:91], v9, s[76:79], s83 offen sc1
    s_mov_b32 s83, 9856
    buffer_load_dwordx4 v[92:95], v9, s[76:79], s83 offen sc1
    s_waitcnt vmcnt(0)
    v_max_u32 v7, v64, v65
    v_max3_u32 v7, v7, v66, v67
    v_max3_u32 v7, v7, v68, v69
    v_max3_u32 v7, v7, v70, v71
    v_max3_u32 v7, v7, v72, v73
    v_max3_u32 v7, v7, v74, v75
    v_max3_u32 v7, v7, v76, v77
    v_max3_u32 v7, v7, v78, v79
    v_max3_u32 v7, v7, v80, v81
    v_max3_u32 v7, v7, v82, v83
    v_max3_u32 v7, v7, v84, v85
    v_max3_u32 v7, v7, v86, v87
    v_max3_u32 v7, v7, v88, v89
    v_max3_u32 v7, v7, v90, v91
    v_max3_u32 v7, v7, v92, v93
    v_max3_u32 v7, v7, v94, v95
    v_cmp_eq_u32 vcc, -1, v7
    s_nop 4
    s_cbranch_vccz L_pdone_15
    s_sub_u32 s94, s94, 1
    s_cmp_eq_u32 s94, 0
    s_cbranch_scc1 L_pdone_15
    s_sleep 1
    s_branch L_poll_14
L_pdone_15:
    v_add_f32 v64, v64, v68
    v_add_f32 v65, v65, v69
    v_add_f32 v66, v66, v70
    v_add_f32 v67, v67, v71
    v_add_f32 v72, v72, v76
    v_add_f32 v73, v73, v77
    v_add_f32 v74, v74, v78
    v_add_f32 v75, v75, v79
    v_add_f32 v80, v80, v84
    v_add_f32 v81, v81, v85
    v_add_f32 v82, v82, v86
    v_add_f32 v83, v83, v87
    v_add_f32 v88, v88, v92
    v_add_f32 v89, v89, v93
    v_add_f32 v90, v90, v94
    v_add_f32 v91, v91, v95
    v_add_f32 v64, v64, v72
    v_add_f32 v65, v65, v73
    v_add_f32 v66, v66, v74
    v_add_f32 v67, v67, v75
    v_add_f32 v80, v80, v88
    v_add_f32 v81, v81, v89
    v_add_f32 v82, v82, v90
    v_add_f32 v83, v83, v91
    v_add_f32 v64, v64, v80
    v_add_f32 v65, v65, v81
    v_add_f32 v66, v66, v82
    v_add_f32 v67, v67, v83
    v_cvt_pk_bf16_f32 v20, v64, v65
    v_cvt_pk_bf16_f32 v21, v66, v67
    v_lshlrev_b32 v5, 3, v3
    s_and_saveexec_b64 s[96:97], s[90:91]
    ds_write_b64 v5, v[20:21] offset:12864
    s_mov_b64 exec, s[96:97]
    s_waitcnt lgkmcnt(0)
    s_barrier
    s_branch L_end
L_h1:
    v_mov_b32 v9, 13304
    v_mov_b32 v10, 1
    ds_write_b32 v9, v10
    s_mov_b32 s83, 15360
    buffer_load_dwordx4 v[64:67], v57, s[48:51], s83 offen nt
    buffer_load_dwordx4 v[68:71], v57, s[52:55], s83 offen nt
    s_mov_b32 s83, 18432
    buffer_load_dwordx4 v[72:75], v57, s[48:51], s83 offen nt
    buffer_load_dwordx4 v[76:79], v57, s[52:55], s83 offen nt
    s_mov_b32 s83, 21504
    buffer_load_dwordx4 v[80:83], v57, s[48:51], s83 offen nt
    buffer_load_dwordx4 v[84:87], v57, s[52:55], s83 offen nt
    s_mov_b32 s83, 24576
    buffer_load_dwordx4 v[88:91], v57, s[48:51], s83 offen nt
    buffer_load_dwordx4 v[92:95], v57, s[52:55], s83 offen nt
    s_mov_b32 s83, 27648
    buffer_load_dwordx4 v[96:99], v57, s[48:51], s83 offen nt
    buffer_load_dwordx4 v[100:103], v57, s[52:55], s83 offen nt
    v_mov_b32 v20, 0
    v_mov_b32 v21, 0
    v_mov_b32 v22, 0
    v_mov_b32 v23, 0
    v_mov_b32 v24, 0
    v_mov_b32 v25, 0
    v_mov_b32 v26, 0
    v_mov_b32 v27, 0
    v_mov_b32 v28, 0
    v_mov_b32 v29, 0
    v_mov_b32 v30, 0
    v_mov_b32 v31, 0
    v_mov_b32 v32, 0
    v_mov_b32 v33, 0
    v_mov_b32 v34, 0
    v_mov_b32 v35, 0
    s_waitcnt vmcnt(18)
    v_lshlrev_b32 v5, 16, v12
    v_lshlrev_b32 v6, 16, v124
    v_and_b32 v7, s84, v124
    v_fmac_f32 v20, v5, v6
    v_fmac_f32 v21, v5, v7
    v_lshlrev_b32 v6, 16, v125
    v_and_b32 v7, s84, v125
    v_fmac_f32 v22, v5, v6
    v_fmac_f32 v23, v5, v7
    v_lshlrev_b32 v6, 16, v126
    v_and_b32 v7, s84, v126
    v_fmac_f32 v24, v5, v6
    v_fmac_f32 v25, v5, v7
    v_lshlrev_b32 v6, 16, v127
    v_and_b32 v7, s84, v127
    v_fmac_f32 v26, v5, v6
    v_fmac_f32 v27, v5, v7
    v_lshlrev_b32 v6, 16, v128
    v_and_b32 v7, s84, v128
    v_fmac_f32 v28, v5, v6
    v_fmac_f32 v29, v5, v7
    v_lshlrev_b32 v6, 16, v129
    v_and_b32 v7, s84, v129
    v_fmac_f32 v30, v5, v6
    v_fmac_f32 v31, v5, v7
    v_lshlrev_b32 v6, 16, v130
    v_and_b32 v7, s84, v130
    v_fmac_f32 v32, v5, v6
    v_fmac_f32 v33, v5, v7
    v_lshlrev_b32 v6, 16, v131
    v_and_b32 v7, s84, v131
    v_fmac_f32 v34, v5, v6
    v_fmac_f32 v35, v5, v7
    s_waitcnt vmcnt(16)
    v_and_b32 v5, s84, v12
    v_lshlrev_b32 v6, 16, v132
    v_and_b32 v7, s84, v132
    v_fmac_f32 v20, v5, v6
    v_fmac_f32 v21, v5, v7
    v_lshlrev_b32 v6, 16, v133
    v_and_b32 v7, s84, v133
    v_fmac_f32 v22, v5, v6
    v_fmac_f32 v23, v5, v7
    v_lshlrev_b32 v6, 16, v134
    v_and_b32 v7, s84, v134
    v_fmac_f32 v24, v5, v6
    v_fmac_f32 v25, v5, v7
    v_lshlrev_b32 v6, 16, v135
    v_and_b32 v7, s84, v135
    v_fmac_f32 v26, v5, v6
    v_fmac_f32 v27, v5, v7
    v_lshlrev_b32 v6, 16, v136
    v_and_b32 v7, s84, v136
    v_fmac_f32 v28, v5, v6
    v_fmac_f32 v29, v5, v7
    v_lshlrev_b32 v6, 16, v137
    v_and_b32 v7, s84, v137
    v_fmac_f32 v30, v5, v6
    v_fmac_f32 v31, v5, v7
    v_lshlrev_b32 v6, 16, v138
    v_and_b32 v7, s84, v138
    v_fmac_f32 v32, v5, v6
    v_fmac_f32 v33, v5, v7
    v_lshlrev_b32 v6, 16, v139
    v_and_b32 v7, s84, v139
    v_fmac_f32 v34, v5, v6
    v_fmac_f32 v35, v5, v7
    s_waitcnt vmcnt(14)
    v_lshlrev_b32 v5, 16, v13
    v_lshlrev_b32 v6, 16, v140
    v_and_b32 v7, s84, v140
    v_fmac_f32 v20, v5, v6
    v_fmac_f32 v21, v5, v7
    v_lshlrev_b32 v6, 16, v141
    v_and_b32 v7, s84, v141
    v_fmac_f32 v22, v5, v6
    v_fmac_f32 v23, v5, v7
    v_lshlrev_b32 v6, 16, v142
    v_and_b32 v7, s84, v142
    v_fmac_f32 v24, v5, v6
    v_fmac_f32 v25, v5, v7
    v_lshlrev_b32 v6, 16, v143
    v_and_b32 v7, s84, v143
    v_fmac_f32 v26, v5, v6
    v_fmac_f32 v27, v5, v7
    v_lshlrev_b32 v6, 16, v144
    v_and_b32 v7, s84, v144
    v_fmac_f32 v28, v5, v6
    v_fmac_f32 v29, v5, v7
    v_lshlrev_b32 v6, 16, v145
    v_and_b32 v7, s84, v145
    v_fmac_f32 v30, v5, v6
    v_fmac_f32 v31, v5, v7
    v_lshlrev_b32 v6, 16, v146
    v_and_b32 v7, s84, v146
    v_fmac_f32 v32, v5, v6
    v_fmac_f32 v33, v5, v7
    v_lshlrev_b32 v6, 16, v147
    v_and_b32 v7, s84, v147
    v_fmac_f32 v34, v5, v6
    v_fmac_f32 v35, v5, v7
    s_waitcnt vmcnt(12)
    v_and_b32 v5, s84, v13
    v_lshlrev_b32 v6, 16, v148
    v_and_b32 v7, s84, v148
    v_fmac_f32 v20, v5, v6
    v_fmac_f32 v21, v5, v7
    v_lshlrev_b32 v6, 16, v149
    v_and_b32 v7, s84, v149
    v_fmac_f32 v22, v5, v6
    v_fmac_f32 v23, v5, v7
    v_lshlrev_b32 v6, 16, v150
    v_and_b32 v7, s84, v150
    v_fmac_f32 v24, v5, v6
    v_fmac_f32 v25, v5, v7
    v_lshlrev_b32 v6, 16, v151
    v_and_b32 v7, s84, v151
    v_fmac_f32 v26, v5, v6
    v_fmac_f32 v27, v5, v7
    v_lshlrev_b32 v6, 16, v152
    v_and_b32 v7, s84, v152
    v_fmac_f32 v28, v5, v6
    v_fmac_f32 v29, v5, v7
    v_lshlrev_b32 v6, 16, v153
    v_and_b32 v7, s84, v153
    v_fmac_f32 v30, v5, v6
    v_fmac_f32 v31, v5, v7
    v_lshlrev_b32 v6, 16, v154
    v_and_b32 v7, s84, v154
    v_fmac_f32 v32, v5, v6
    v_fmac_f32 v33, v5, v7
    v_lshlrev_b32 v6, 16, v155
    v_and_b32 v7, s84, v155
    v_fmac_f32 v34, v5, v6
    v_fmac_f32 v35, v5, v7
    s_waitcnt vmcnt(10)
    v_lshlrev_b32 v5, 16, v14
    v_lshlrev_b32 v6, 16, v156
    v_and_b32 v7, s84, v156
    v_fmac_f32 v20, v5, v6
    v_fmac_f32 v21, v5, v7
    v_lshlrev_b32 v6, 16, v157
    v_and_b32 v7, s84, v157
    v_fmac_f32 v22, v5, v6
    v_fmac_f32 v23, v5, v7
    v_lshlrev_b32 v6, 16, v158
    v_and_b32 v7, s84, v158
    v_fmac_f32 v24, v5, v6
    v_fmac_f32 v25, v5, v7
    v_lshlrev_b32 v6, 16, v159
    v_and_b32 v7, s84, v159
    v_fmac_f32 v26, v5, v6
    v_fmac_f32 v27, v5, v7
    v_lshlrev_b32 v6, 16, v160
    v_and_b32 v7, s84, v160
    v_fmac_f32 v28, v5, v6
    v_fmac_f32 v29, v5, v7
    v_lshlrev_b32 v6, 16, v161
    v_and_b32 v7, s84, v161
    v_fmac_f32 v30, v5, v6
    v_fmac_f32 v31, v5, v7
    v_lshlrev_b32 v6, 16, v162
    v_and_b32 v7, s84, v162
    v_fmac_f32 v32, v5, v6
    v_fmac_f32 v33, v5, v7
    v_lshlrev_b32 v6, 16, v163
    v_and_b32 v7, s84, v163
    v_fmac_f32 v34, v5, v6
    v_fmac_f32 v35, v5, v7
    s_waitcnt vmcnt(8)
    v_and_b32 v5, s84, v14
    v_lshlrev_b32 v6, 16, v64
    v_and_b32 v7, s84, v64
    v_fmac_f32 v20, v5, v6
    v_fmac_f32 v21, v5, v7
    v_lshlrev_b32 v6, 16, v65
    v_and_b32 v7, s84, v65
    v_fmac_f32 v22, v5, v6
    v_fmac_f32 v23, v5, v7
    v_lshlrev_b32 v6, 16, v66
    v_and_b32 v7, s84, v66
    v_fmac_f32 v24, v5, v6
    v_fmac_f32 v25, v5, v7
    v_lshlrev_b32 v6, 16, v67
    v_and_b32 v7, s84, v67
    v_fmac_f32 v26, v5, v6
    v_fmac_f32 v27, v5, v7
    v_lshlrev_b32 v6, 16, v68
    v_and_b32 v7, s84, v68
    v_fmac_f32 v28, v5, v6
    v_fmac_f32 v29, v5, v7
    v_lshlrev_b32 v6, 16, v69
    v_and_b32 v7, s84, v69
    v_fmac_f32 v30, v5, v6
    v_fmac_f32 v31, v5, v7
    v_lshlrev_b32 v6, 16, v70
    v_and_b32 v7, s84, v70
    v_fmac_f32 v32, v5, v6
    v_fmac_f32 v33, v5, v7
    v_lshlrev_b32 v6, 16, v71
    v_and_b32 v7, s84, v71
    v_fmac_f32 v34, v5, v6
    v_fmac_f32 v35, v5, v7
    s_waitcnt vmcnt(6)
    v_lshlrev_b32 v5, 16, v15
    v_lshlrev_b32 v6, 16, v72
    v_and_b32 v7, s84, v72
    v_fmac_f32 v20, v5, v6
    v_fmac_f32 v21, v5, v7
    v_lshlrev_b32 v6, 16, v73
    v_and_b32 v7, s84, v73
    v_fmac_f32 v22, v5, v6
    v_fmac_f32 v23, v5, v7
    v_lshlrev_b32 v6, 16, v74
    v_and_b32 v7, s84, v74
    v_fmac_f32 v24, v5, v6
    v_fmac_f32 v25, v5, v7
    v_lshlrev_b32 v6, 16, v75
    v_and_b32 v7, s84, v75
    v_fmac_f32 v26, v5, v6
    v_fmac_f32 v27, v5, v7
    v_lshlrev_b32 v6, 16, v76
    v_and_b32 v7, s84, v76
    v_fmac_f32 v28, v5, v6
    v_fmac_f32 v29, v5, v7
    v_lshlrev_b32 v6, 16, v77
    v_and_b32 v7, s84, v77
    v_fmac_f32 v30, v5, v6
    v_fmac_f32 v31, v5, v7
    v_lshlrev_b32 v6, 16, v78
    v_and_b32 v7, s84, v78
    v_fmac_f32 v32, v5, v6
    v_fmac_f32 v33, v5, v7
    v_lshlrev_b32 v6, 16, v79
    v_and_b32 v7, s84, v79
    v_fmac_f32 v34, v5, v6
    v_fmac_f32 v35, v5, v7
    s_waitcnt vmcnt(4)
    v_and_b32 v5, s84, v15
    v_lshlrev_b32 v6, 16, v80
    v_and_b32 v7, s84, v80
    v_fmac_f32 v20, v5, v6
    v_fmac_f32 v21, v5, v7
    v_lshlrev_b32 v6, 16, v81
    v_and_b32 v7, s84, v81
    v_fmac_f32 v22, v5, v6
    v_fmac_f32 v23, v5, v7
    v_lshlrev_b32 v6, 16, v82
    v_and_b32 v7, s84, v82
    v_fmac_f32 v24, v5, v6
    v_fmac_f32 v25, v5, v7
    v_lshlrev_b32 v6, 16, v83
    v_and_b32 v7, s84, v83
    v_fmac_f32 v26, v5, v6
    v_fmac_f32 v27, v5, v7
    v_lshlrev_b32 v6, 16, v84
    v_and_b32 v7, s84, v84
    v_fmac_f32 v28, v5, v6
    v_fmac_f32 v29, v5, v7
    v_lshlrev_b32 v6, 16, v85
    v_and_b32 v7, s84, v85
    v_fmac_f32 v30, v5, v6
    v_fmac_f32 v31, v5, v7
    v_lshlrev_b32 v6, 16, v86
    v_and_b32 v7, s84, v86
    v_fmac_f32 v32, v5, v6
    v_fmac_f32 v33, v5, v7
    v_lshlrev_b32 v6, 16, v87
    v_and_b32 v7, s84, v87
    v_fmac_f32 v34, v5, v6
    v_fmac_f32 v35, v5, v7
    s_waitcnt vmcnt(2)
    v_lshlrev_b32 v5, 16, v16
    v_lshlrev_b32 v6, 16, v88
    v_and_b32 v7, s84, v88
    v_fmac_f32 v20, v5, v6
    v_fmac_f32 v21, v5, v7
    v_lshlrev_b32 v6, 16, v89
    v_and_b32 v7, s84, v89
    v_fmac_f32 v22, v5, v6
    v_fmac_f32 v23, v5, v7
    v_lshlrev_b32 v6, 16, v90
    v_and_b32 v7, s84, v90
    v_fmac_f32 v24, v5, v6
    v_fmac_f32 v25, v5, v7
    v_lshlrev_b32 v6, 16, v91
    v_and_b32 v7, s84, v91
    v_fmac_f32 v26, v5, v6
    v_fmac_f32 v27, v5, v7
    v_lshlrev_b32 v6, 16, v92
    v_and_b32 v7, s84, v92
    v_fmac_f32 v28, v5, v6
    v_fmac_f32 v29, v5, v7
    v_lshlrev_b32 v6, 16, v93
    v_and_b32 v7, s84, v93
    v_fmac_f32 v30, v5, v6
    v_fmac_f32 v31, v5, v7
    v_lshlrev_b32 v6, 16, v94
    v_and_b32 v7, s84, v94
    v_fmac_f32 v32, v5, v6
    v_fmac_f32 v33, v5, v7
    v_lshlrev_b32 v6, 16, v95
    v_and_b32 v7, s84, v95
    v_fmac_f32 v34, v5, v6
    v_fmac_f32 v35, v5, v7
    s_waitcnt vmcnt(0)
    v_and_b32 v5, s84, v16
    v_lshlrev_b32 v6, 16, v96
    v_and_b32 v7, s84, v96
    v_fmac_f32 v20, v5, v6
    v_fmac_f32 v21, v5, v7
    v_lshlrev_b32 v6, 16, v97
    v_and_b32 v7, s84, v97
    v_fmac_f32 v22, v5, v6
    v_fmac_f32 v23, v5, v7
    v_lshlrev_b32 v6, 16, v98
    v_and_b32 v7, s84, v98
    v_fmac_f32 v24, v5, v6
    v_fmac_f32 v25, v5, v7
    v_lshlrev_b32 v6, 16, v99
    v_and_b32 v7, s84, v99
    v_fmac_f32 v26, v5, v6
    v_fmac_f32 v27, v5, v7
    v_lshlrev_b32 v6, 16, v100
    v_and_b32 v7, s84, v100
    v_fmac_f32 v28, v5, v6
    v_fmac_f32 v29, v5, v7
    v_lshlrev_b32 v6, 16, v101
    v_and_b32 v7, s84, v101
    v_fmac_f32 v30, v5, v6
    v_fmac_f32 v31, v5, v7
    v_lshlrev_b32 v6, 16, v102
    v_and_b32 v7, s84, v102
    v_fmac_f32 v32, v5, v6
    v_fmac_f32 v33, v5, v7
    v_lshlrev_b32 v6, 16, v103
    v_and_b32 v7, s84, v103
    v_fmac_f32 v34, v5, v6
    v_fmac_f32 v35, v5, v7
    s_nop 1
    v_permlane32_swap_b32 v20, v28
    v_permlane32_swap_b32 v21, v29
    v_permlane32_swap_b32 v22, v30
    v_permlane32_swap_b32 v23, v31
    v_permlane32_swap_b32 v24, v32
    v_permlane32_swap_b32 v25, v33
    v_permlane32_swap_b32 v26, v34
    v_permlane32_swap_b32 v27, v35
    v_add_f32 v20, v20, v28
    v_add_f32 v21, v21, v29
    v_add_f32 v22, v22, v30
    v_add_f32 v23, v23, v31
    v_add_f32 v24, v24, v32
    v_add_f32 v25, v25, v33
    v_add_f32 v26, v26, v34
    v_add_f32 v27, v27, v35
    s_nop 1
    v_permlane16_swap_b32 v20, v24
    v_permlane16_swap_b32 v21, v25
    v_permlane16_swap_b32 v22, v26
    v_permlane16_swap_b32 v23, v27
    v_add_f32 v20, v20, v24
    v_add_f32 v21, v21, v25
    v_add_f32 v22, v22, v26
    v_add_f32 v23, v23, v27
    s_nop 1
    v_add_f32_dpp v20, v20, v20 row_ror:8 row_mask:0xf bank_mask:0xf
    v_add_f32_dpp v21, v21, v21 row_ror:8 row_mask:0xf bank_mask:0xf
    v_add_f32_dpp v22, v22, v22 row_ror:8 row_mask:0xf bank_mask:0xf
    v_add_f32_dpp v23, v23, v23 row_ror:8 row_mask:0xf bank_mask:0xf
    v_mov_b32 v12, 0x7fc00000
    v_cmp_eq_u32 vcc, -1, v20
    s_nop 1
    v_cndmask_b32 v20, v20, v12, vcc
    v_cmp_eq_u32 vcc, -1, v21
    s_nop 1
    v_cndmask_b32 v21, v21, v12, vcc
    v_cmp_eq_u32 vcc, -1, v22
    s_nop 1
    v_cndmask_b32 v22, v22, v12, vcc
    v_cmp_eq_u32 vcc, -1, v23
    s_nop 1
    v_cndmask_b32 v23, v23, v12, vcc
    v_lshrrev_b32 v5, 5, v3
    v_mul_u32_u24 v5, 256, v5
    v_bfe_u32 v6, v3, 4, 1
    v_lshl_add_u32 v5, v6, 4, v5
    v_and_b32 v6, 15, v3
    v_lshl_add_u32 v5, v6, 5, v5
    s_mul_i32 s87, s95, 1408
    s_add_u32 s87, s87, 525056
    v_add_u32 v5, s87, v5
    v_cmp_gt_u32 vcc, 8, v6
    s_nop 1
    v_cndmask_b32 v5, v63, v5, vcc
    v_mov_b32 v6, 13300
    s_mov_b32 s94, 3200000
L_h1flag:
    ds_read_b32 v7, v6
    s_waitcnt lgkmcnt(0)
    v_readfirstlane_b32 s30, v7
    s_sub_u32 s94, s94, 1
    s_cmp_eq_u32 s94, 0
    s_cbranch_scc1 L_h1st
    s_cmp_eq_u32 s30, 0
    s_cbranch_scc1 L_h1flag
L_h1st:
    buffer_store_dwordx4 v[20:23], v5, s[76:79], 0 offen sc1
    v_mul_u32_u24 v4, 20, v3
    buffer_load_dwordx4 v[44:47], v4, s[60:63], 0 offen
    buffer_load_dword v48, v4, s[60:63], 0 offen offset:16
    buffer_load_dwordx4 v[52:55], v4, s[64:67], 0 offen
    buffer_load_dword v56, v4, s[64:67], 0 offen offset:16
    s_waitcnt lgkmcnt(0)
    s_barrier
    s_lshl_b32 s87, s81, 5
    s_add_u32 s87, s87, 4
    v_mov_b32 v10, s87
    v_cmp_eq_u32 vcc, 0, v3
    v_mov_b32 v12, 1
    s_nop 0
    v_cndmask_b32 v10, v63, v10, vcc
    buffer_atomic_add v12, v10, s[72:75], 0 offen
    v_and_b32 v5, 15, v3
    v_lshlrev_b32 v6, 4, v5
    v_lshrrev_b32 v7, 4, v3
    v_mul_u32_u24 v9, 256, v7
    v_add_u32 v6, v6, v9
    s_mul_i32 s87, s80, 11264
    s_add_u32 s87, s87, 525056
    v_add_u32 v6, s87, v6
    v_cmp_gt_u32 vcc, 32, v3
    s_nop 1
    v_cndmask_b32 v6, v63, v6, vcc
    s_mov_b32 s94, 400000
L_poll_16:
    s_mov_b32 s83, 0
    buffer_load_dwordx4 v[64:67], v6, s[76:79], s83 offen sc1
    s_mov_b32 s83, 1408
    buffer_load_dwordx4 v[68:71], v6, s[76:79], s83 offen sc1
    s_mov_b32 s83, 2816
    buffer_load_dwordx4 v[72:75], v6, s[76:79], s83 offen sc1
    s_mov_b32 s83, 4224
    buffer_load_dwordx4 v[76:79], v6, s[76:79], s83 offen sc1
    s_mov_b32 s83, 5632
    buffer_load_dwordx4 v[80:83], v6, s[76:79], s83 offen sc1
    s_mov_b32 s83, 7040
    buffer_load_dwordx4 v[84:87], v6, s[76:79], s83 offen sc1
    s_mov_b32 s83, 8448
    buffer_load_dwordx4 v[88:91], v6, s[76:79], s83 offen sc1
    s_mov_b32 s83, 9856
    buffer_load_dwordx4 v[92:95], v6, s[76:79], s83 offen sc1
    s_waitcnt vmcnt(0)
    v_max_u32 v7, v64, v65
    v_max3_u32 v7, v7, v66, v67
    v_max3_u32 v7, v7, v68, v69
    v_max3_u32 v7, v7, v70, v71
    v_max3_u32 v7, v7, v72, v73
    v_max3_u32 v7, v7, v74, v75
    v_max3_u32 v7, v7, v76, v77
    v_max3_u32 v7, v7, v78, v79
    v_max3_u32 v7, v7, v80, v81
    v_max3_u32 v7, v7, v82, v83
    v_max3_u32 v7, v7, v84, v85
    v_max3_u32 v7, v7, v86, v87
    v_max3_u32 v7, v7, v88, v89
    v_max3_u32 v7, v7, v90, v91
    v_max3_u32 v7, v7, v92, v93
    v_max3_u32 v7, v7, v94, v95
    v_cmp_eq_u32 vcc, -1, v7
    s_nop 4
    s_cbranch_vccz L_pdone_17
    s_sub_u32 s94, s94, 1
    s_cmp_eq_u32 s94, 0
    s_cbranch_scc1 L_pdone_17
    s_sleep 1
    s_branch L_poll_16
L_pdone_17:
    v_add_f32 v64, v64, v68
    v_add_f32 v65, v65, v69
    v_add_f32 v66, v66, v70
    v_add_f32 v67, v67, v71
    v_add_f32 v72, v72, v76
    v_add_f32 v73, v73, v77
    v_add_f32 v74, v74, v78
    v_add_f32 v75, v75, v79
    v_add_f32 v80, v80, v84
    v_add_f32 v81, v81, v85
    v_add_f32 v82, v82, v86
    v_add_f32 v83, v83, v87
    v_add_f32 v88, v88, v92
    v_add_f32 v89, v89, v93
    v_add_f32 v90, v90, v94
    v_add_f32 v91, v91, v95
    v_add_f32 v64, v64, v72
    v_add_f32 v65, v65, v73
    v_add_f32 v66, v66, v74
    v_add_f32 v67, v67, v75
    v_add_f32 v80, v80, v88
    v_add_f32 v81, v81, v89
    v_add_f32 v82, v82, v90
    v_add_f32 v83, v83, v91
    v_add_f32 v64, v64, v80
    v_add_f32 v65, v65, v81
    v_add_f32 v66, v66, v82
    v_add_f32 v67, v67, v83
    v_cvt_pk_bf16_f32 v64, v64, v64
    v_lshlrev_b32 v64, 16, v64
    v_cvt_pk_bf16_f32 v65, v65, v65
    v_lshlrev_b32 v65, 16, v65
    v_cvt_pk_bf16_f32 v66, v66, v66
    v_lshlrev_b32 v66, 16, v66
    v_cvt_pk_bf16_f32 v67, v67, v67
    v_lshlrev_b32 v67, 16, v67
    v_mov_b32 v68, v64
    v_mov_b32 v69, v65
    v_mov_b32 v70, v66
    v_mov_b32 v71, v67
    s_nop 1
    v_permlane16_swap_b32 v64, v68
    v_permlane16_swap_b32 v65, v69
    v_permlane16_swap_b32 v66, v70
    v_permlane16_swap_b32 v67, v71
    v_mul_f32 v20, s85, v64
    v_sub_f32 v20, 0, v20
    v_exp_f32 v20, v20
    s_nop 0
    v_add_f32 v20, 1.0, v20
    v_rcp_f32 v20, v20
    s_nop 0
    v_mul_f32 v20, v64, v20
    v_cvt_pk_bf16_f32 v20, v20, v20
    v_lshlrev_b32 v20, 16, v20
    v_mul_f32 v20, v20, v68
    v_cvt_pk_bf16_f32 v20, v20, v20
    v_lshlrev_b32 v20, 16, v20
    v_mul_f32 v21, s85, v65
    v_sub_f32 v21, 0, v21
    v_exp_f32 v21, v21
    s_nop 0
    v_add_f32 v21, 1.0, v21
    v_rcp_f32 v21, v21
    s_nop 0
    v_mul_f32 v21, v65, v21
    v_cvt_pk_bf16_f32 v21, v21, v21
    v_lshlrev_b32 v21, 16, v21
    v_mul_f32 v21, v21, v69
    v_cvt_pk_bf16_f32 v21, v21, v21
    v_lshlrev_b32 v21, 16, v21
    v_mul_f32 v22, s85, v66
    v_sub_f32 v22, 0, v22
    v_exp_f32 v22, v22
    s_nop 0
    v_add_f32 v22, 1.0, v22
    v_rcp_f32 v22, v22
    s_nop 0
    v_mul_f32 v22, v66, v22
    v_cvt_pk_bf16_f32 v22, v22, v22
    v_lshlrev_b32 v22, 16, v22
    v_mul_f32 v22, v22, v70
    v_cvt_pk_bf16_f32 v22, v22, v22
    v_lshlrev_b32 v22, 16, v22
    v_mul_f32 v23, s85, v67
    v_sub_f32 v23, 0, v23
    v_exp_f32 v23, v23
    s_nop 0
    v_add_f32 v23, 1.0, v23
    v_rcp_f32 v23, v23
    s_nop 0
    v_mul_f32 v23, v67, v23
    v_cvt_pk_bf16_f32 v23, v23, v23
    v_lshlrev_b32 v23, 16, v23
    v_mul_f32 v23, v23, v71
    v_cvt_pk_bf16_f32 v23, v23, v23
    v_lshlrev_b32 v23, 16, v23
    v_cmp_gt_u32 vcc, 16, v3
    s_and_saveexec_b64 s[96:97], vcc
    ds_write_b128 v8, v[20:23] offset:12352
    s_mov_b64 exec, s[96:97]
    v_mov_b32 v20, 0
    v_lshlrev_b32 v5, 16, v44
    v_lshlrev_b32 v6, 16, v52
    v_mul_f32 v6, v5, v6
    v_cvt_pk_bf16_f32 v6, v6, v6
    v_lshlrev_b32 v6, 16, v6
    v_add_f32 v20, v20, v6
    v_and_b32 v5, s84, v44
    v_and_b32 v6, s84, v52
    v_mul_f32 v6, v5, v6
    v_cvt_pk_bf16_f32 v6, v6, v6
    v_lshlrev_b32 v6, 16, v6
    v_add_f32 v20, v20, v6
    v_lshlrev_b32 v5, 16, v45
    v_lshlrev_b32 v6, 16, v53
    v_mul_f32 v6, v5, v6
    v_cvt_pk_bf16_f32 v6, v6, v6
    v_lshlrev_b32 v6, 16, v6
    v_add_f32 v20, v20, v6
    v_and_b32 v5, s84, v45
    v_and_b32 v6, s84, v53
    v_mul_f32 v6, v5, v6
    v_cvt_pk_bf16_f32 v6, v6, v6
    v_lshlrev_b32 v6, 16, v6
    v_add_f32 v20, v20, v6
    v_lshlrev_b32 v5, 16, v46
    v_lshlrev_b32 v6, 16, v54
    v_mul_f32 v6, v5, v6
    v_cvt_pk_bf16_f32 v6, v6, v6
    v_lshlrev_b32 v6, 16, v6
    v_add_f32 v20, v20, v6
    v_and_b32 v5, s84, v46
    v_and_b32 v6, s84, v54
    v_mul_f32 v6, v5, v6
    v_cvt_pk_bf16_f32 v6, v6, v6
    v_lshlrev_b32 v6, 16, v6
    v_add_f32 v20, v20, v6
    v_lshlrev_b32 v5, 16, v47
    v_lshlrev_b32 v6, 16, v55
    v_mul_f32 v6, v5, v6
    v_cvt_pk_bf16_f32 v6, v6, v6
    v_lshlrev_b32 v6, 16, v6
    v_add_f32 v20, v20, v6
    v_and_b32 v5, s84, v47
    v_and_b32 v6, s84, v55
    v_mul_f32 v6, v5, v6
    v_cvt_pk_bf16_f32 v6, v6, v6
    v_lshlrev_b32 v6, 16, v6
    v_add_f32 v20, v20, v6
    v_lshlrev_b32 v5, 16, v48
    v_lshlrev_b32 v6, 16, v56
    v_mul_f32 v6, v5, v6
    v_cvt_pk_bf16_f32 v6, v6, v6
    v_lshlrev_b32 v6, 16, v6
    v_add_f32 v20, v20, v6
    v_and_b32 v5, s84, v48
    v_and_b32 v6, s84, v56
    v_mul_f32 v6, v5, v6
    v_cvt_pk_bf16_f32 v6, v6, v6
    v_lshlrev_b32 v6, 16, v6
    v_add_f32 v20, v20, v6
    v_mov_b32 v21, v20
    s_nop 1
    v_permlane32_swap_b32 v20, v21
    v_add_f32 v20, v20, v21
    v_mov_b32 v21, v20
    s_nop 1
    v_permlane16_swap_b32 v20, v21
    v_add_f32 v20, v20, v21
    s_nop 1
    v_add_f32_dpp v20, v20, v20 row_ror:8 row_mask:0xf bank_mask:0xf
    s_nop 1
    v_add_f32_dpp v20, v20, v20 row_ror:4 row_mask:0xf bank_mask:0xf
    s_nop 1
    v_add_f32_dpp v20, v20, v20 row_ror:2 row_mask:0xf bank_mask:0xf
    s_nop 1
    v_add_f32_dpp v20, v20, v20 row_ror:1 row_mask:0xf bank_mask:0xf
    v_cvt_pk_bf16_f32 v20, v20, v20
    v_lshlrev_b32 v20, 16, v20
    v_mul_f32 v22, s85, v20
    v_sub_f32 v22, 0, v22
    v_exp_f32 v22, v22
    s_nop 0
    v_add_f32 v22, 1.0, v22
    v_rcp_f32 v22, v22
    s_nop 0
    v_cvt_pk_bf16_f32 v22, v22, v22
    v_lshlrev_b32 v22, 16, v22
    v_mov_b32 v4, 13308
    ds_write_b32 v4, v22
    s_waitcnt lgkmcnt(0)
    s_barrier
    s_branch L_end
L_end:
    s_endpgm
.section .rodata,"a"
.p2align 6
.amdhsa_kernel gated_mix__mha_block_cached__glu_gated_swiglu__decode_kernel
  .amdhsa_next_free_vgpr 168
  .amdhsa_next_free_sgpr 102
  .amdhsa_accum_offset 168
  .amdhsa_group_segment_fixed_size 0
  .amdhsa_kernarg_size 104
  .amdhsa_user_sgpr_count 2
  .amdhsa_user_sgpr_kernarg_segment_ptr 1
  .amdhsa_system_sgpr_workgroup_id_x 1
  .amdhsa_float_denorm_mode_32 3
.end_amdhsa_kernel
```
